```python
import torch

def _softmax(x, axis=-1):
    return torch.softmax(x, dim=axis)

def _gelu(x):
    return torch.nn.functional.gelu(x, approximate='tanh')

def _silu(x):
    return torch.nn.functional.silu(x)

def _sigmoid(x):
    return torch.sigmoid(x)

def _layernorm(x, axis=-1, eps=1e-05):
    m = x.mean(dim=axis, keepdim=True)
    v = x.var(dim=axis, keepdim=True, unbiased=False)
    return (x - m) / torch.sqrt(v + eps)

def _scatter_add(tgt, idx, src, axis=0):
    return tgt.clone().index_add_(axis, idx, src)

def _segment_sum(src, seg, n):
    out = torch.zeros((n,) + src.shape[1:], dtype=src.dtype)
    return out.index_add_(0, seg, src)

def _pad(x, pw):
    flat = tuple((v for pair in reversed(pw) for v in pair))
    return torch.nn.functional.pad(x, flat)
kernel_name = 'standalone__video_video_swin__vision'

def setup_inputs():

    _w = lambda a: (lambda t: t.to(torch.bfloat16) if t.is_floating_point() else t)(torch.as_tensor(a))
    T = 4
    H = W = 384 // 8 * 8
    C, win = (96, 8)
    return {'x': _w((lambda *s: torch.randn(*s, dtype=torch.bfloat16) * 0.1)(1, T, H, W, C)), 'wqkv_t': _w((lambda *s: torch.randn(*s, dtype=torch.bfloat16) * 0.1)(C, 3 * C)), 'wo_t': _w((lambda *s: torch.randn(*s, dtype=torch.bfloat16) * 0.1)(C, C)), 'wqkv_s': _w((lambda *s: torch.randn(*s, dtype=torch.bfloat16) * 0.1)(C, 3 * C)), 'wo_s': _w((lambda *s: torch.randn(*s, dtype=torch.bfloat16) * 0.05)(C, C))}

def reference(x, wqkv_t, wo_t, wqkv_s, wo_s):
    B, T, H, W, C = x.shape
    win = 8
    scale = C ** (-0.5)
    h = _layernorm(x, axis=-1)
    ht = (lambda x, *d: x.permute(*d))(h, 0, 2, 3, 1, 4).reshape(B * H * W, T, C)
    qkv = ht @ wqkv_t
    q, k, v = (qkv[..., :C].clone(), qkv[..., C:2 * C].clone(), qkv[..., 2 * C:].clone())
    p = _softmax(torch.einsum('btc,bsc->bts', q, k) * scale, axis=-1)
    ot = torch.einsum('bts,bsc->btc', p, v) @ wo_t
    ot = (lambda x, *d: x.permute(*d))(ot.reshape(B, H, W, T, C), 0, 3, 1, 2, 4)
    x = x + ot
    h = _layernorm(x, axis=-1)
    nh, nw = (H // win, W // win)
    hs = h.reshape(B * T, nh, win, nw, win, C)
    hw = (lambda x, *d: x.permute(*d))(hs, 0, 1, 3, 2, 4, 5).reshape(B * T * nh * nw, win * win, C)
    qkv = hw @ wqkv_s
    q, k, v = (qkv[..., :C].clone(), qkv[..., C:2 * C].clone(), qkv[..., 2 * C:].clone())
    p = _softmax(torch.einsum('bqc,bkc->bqk', q, k) * scale, axis=-1)
    os = torch.einsum('bqk,bkc->bqc', p, v) @ wo_s
    os = (lambda x, *d: x.permute(*d))(os.reshape(B * T, nh, nw, win, win, C), 0, 1, 3, 2, 4, 5)
    os = os.reshape(B, T, H, W, C)
    return x + os
```

```asm
; @launch grid=(256,1,1) block=(512,1,1) lds=163840
.amdgcn_target "amdgcn-amd-amdhsa--gfx950"
.text
.globl standalone__video_video_swin__vision_kernel
.p2align 8
.type standalone__video_video_swin__vision_kernel,@function
standalone__video_video_swin__vision_kernel:
    s_cmp_ge_u32 s2, 256
    s_cbranch_scc1 L_end
    s_load_dwordx8 s[20:27], s[0:1], 8
    s_load_dwordx2 s[42:43], s[0:1], 0
    s_load_dwordx2 s[44:45], s[0:1], 40
    s_getpc_b64 s[72:73]
L_pc:
    v_lshlrev_b32 v250, 7, v0
    s_and_b32 s73, s73, 0xffff
    s_mov_b32 s74, L_last-L_pc
    s_mov_b32 s75, 0x20000
    buffer_load_dword v250, v250, s[72:75], 0 offen
    v_lshrrev_b32 v1, 6, v0
    v_and_b32 v0, 63, v0
    s_nop 0
    v_readfirstlane_b32 s16, v1
    v_mov_b32 v4, 162048
    v_mov_b32 v11, 0
    v_lshl_add_u32 v10, v0, 2, v4
    ds_write_b32 v10, v11
    s_bitcmp1_b32 0x87, s16
    s_mov_b32 s60, 5462
    s_cmov_b32 s60, 2731
    s_cselect_b32 s61, 13, 14
    s_mov_b32 s62, 0x70
    s_cselect_b32 s62, s62, 48
    s_mov_b32 s63, 384
    s_cmov_b32 s63, 192
    s_mov_b32 s67, 12288
    s_cmov_b32 s67, 3072
    s_cselect_b32 s66, 2, 3
    s_mul_i32 s64, s16, 18432
    s_cselect_b32 s64, s64, 384
    s_mul_i32 s65, s16, 12288
    s_add_u32 s65, s65, 49152
    s_mov_b32 s70, 55296
    s_mov_b32 s71, 0x20000
    s_cmp_eq_u32 s16, 7
    s_cmov_b32 s64, 0
    s_cmov_b32 s65, 122880
    s_cmov_b32 s66, 6
    s_cmp_eq_u32 s16, 4
    s_cmov_b32 s63, 0
    s_cmov_b32 s64, 0
    s_cmov_b32 s65, 104448
    s_cmov_b32 s67, 0
    s_cmov_b32 s70, 18432
    v_mul_u32_u24 v10, s60, v0
    v_lshlrev_b32 v11, 4, v0
    s_lshl_b32 s60, s60, 6
    v_lshrrev_b32 v12, s61, v10
    v_lshrrev_b32 v13, 16, v10
    v_and_b32 v12, s62, v12
    v_xor_b32 v12, v12, v11
    v_mad_u32_u24 v16, v13, s63, v12
    v_add_u32 v10, s60, v10
    v_lshrrev_b32 v12, s61, v10
    v_lshrrev_b32 v13, 16, v10
    v_and_b32 v12, s62, v12
    v_xor_b32 v12, v12, v11
    v_mad_u32_u24 v17, v13, s63, v12
    v_add_u32 v10, s60, v10
    v_lshrrev_b32 v12, s61, v10
    v_lshrrev_b32 v13, 16, v10
    v_and_b32 v12, s62, v12
    v_xor_b32 v12, v12, v11
    v_mad_u32_u24 v18, v13, s63, v12
    v_add_u32 v10, s60, v10
    v_lshrrev_b32 v12, s61, v10
    v_lshrrev_b32 v13, 16, v10
    v_and_b32 v12, s62, v12
    v_xor_b32 v12, v12, v11
    v_mad_u32_u24 v19, v13, s63, v12
    v_add_u32 v10, s60, v10
    v_lshrrev_b32 v12, s61, v10
    v_lshrrev_b32 v13, 16, v10
    v_and_b32 v12, s62, v12
    v_xor_b32 v12, v12, v11
    v_mad_u32_u24 v20, v13, s63, v12
    v_add_u32 v10, s60, v10
    v_lshrrev_b32 v12, s61, v10
    v_lshrrev_b32 v13, 16, v10
    v_and_b32 v12, s62, v12
    v_xor_b32 v12, v12, v11
    v_mad_u32_u24 v21, v13, s63, v12
    s_cmp_eq_u32 s16, 4
    s_waitcnt lgkmcnt(0)
    s_cselect_b32 s68, s22, s20
    s_cselect_b32 s69, s23, s21
    s_cmp_ge_u32 s16, 6
    s_cselect_b32 s68, s24, s68
    s_cselect_b32 s69, s25, s69
    s_and_b32 s69, s69, 0xffff
    s_cmp_ge_u32 s16, 3
    s_cbranch_scc1 L_g0
L_gl0:
    s_mov_b32 m0, s65
    s_add_u32 s65, s65, 3072
    buffer_load_dwordx4 v16, s[68:71], s64 offen offset:0 lds
    buffer_load_dwordx4 v17, s[68:71], s64 offen offset:1024 lds
    buffer_load_dwordx4 v18, s[68:71], s64 offen offset:2048 lds
    s_add_u32 s64, s64, 3072
    s_mov_b32 m0, s65
    s_add_u32 s65, s65, 3072
    buffer_load_dwordx4 v19, s[68:71], s64 offen offset:0 lds
    buffer_load_dwordx4 v20, s[68:71], s64 offen offset:1024 lds
    buffer_load_dwordx4 v21, s[68:71], s64 offen offset:2048 lds
    s_add_u32 s64, s64, 3072
    s_add_u32 s64, s64, s67
    s_sub_u32 s66, s66, 1
    s_cmp_lg_u32 s66, 0
    s_cbranch_scc1 L_gl0
    s_barrier
L_g0:
    s_cmp_eq_u32 s16, 5
    s_cbranch_scc0 L_nt
    s_lshr_b32 s19, s2, 3
    s_and_b32 s19, s19, 31
    s_mov_b32 s28, s24
    s_mov_b32 s29, s25
    s_mov_b32 s30, 55296
    s_mov_b32 s33, s19
    s_cmp_ge_u32 s19, 7
    s_cselect_b32 s28, s22, s28
    s_cselect_b32 s29, s23, s29
    s_cmov_b32 s30, 18432
    s_cselect_b32 s32, 7, 0
    s_cmp_ge_u32 s19, 10
    s_cselect_b32 s28, s20, s28
    s_cselect_b32 s29, s21, s29
    s_cmov_b32 s30, 55296
    s_cmov_b32 s32, 10
    s_cmp_ge_u32 s19, 17
    s_cselect_b32 s28, s26, s28
    s_cselect_b32 s29, s27, s29
    s_cmov_b32 s30, 18432
    s_cmov_b32 s32, 17
    s_sub_u32 s33, s33, s32
    s_lshl_b32 s33, s33, 13
    s_and_b32 s29, s29, 0xffff
    s_mov_b32 s31, 0x20000
    v_lshl_add_u32 v251, v0, 7, s33
    buffer_load_dword v251, v251, s[28:31], 0 offen
L_nt:
    s_mov_b32 s4, s42
    s_and_b32 s5, s43, 0xffff
    s_mov_b32 s6, 113246208
    s_mov_b32 s7, 0x20000
    s_mov_b32 s8, s44
    s_and_b32 s9, s45, 0xffff
    s_mov_b32 s10, 113246208
    s_mov_b32 s11, 0x20000
    s_mov_b32 s17, 0
    s_mov_b32 s18, s2
    s_mov_b32 s34, 49152
    s_cmp_eq_u32 s16, 6
    s_cbranch_scc1 L_w6
    s_lshl_b32 s19, s16, 1
    s_lshr_b32 s32, 1188, s19
    s_and_b32 s32, s32, 3
    s_mov_b32 s30, 1918907952
    s_mov_b32 s31, 2022337638
    s_lshl_b32 s19, s16, 3
    s_lshr_b64 s[30:31], s[30:31], s19
    s_and_b32 s31, s30, 0xff
    s_lshl_b32 s31, s31, 10
    s_mov_b32 s39, 0
    v_add_u32 v14, 24, v4
    v_and_b32 v10, 7, v0
    v_bfe_u32 v11, v0, 4, 1
    v_lshl_or_b32 v10, v11, 3, v10
    v_lshrrev_b32 v11, 5, v0
    v_lshl_or_b32 v10, v11, 4, v10
    v_bfe_u32 v11, v0, 3, 1
    v_mul_u32_u24 v11, 3072, v11
    v_lshl_add_u32 v3, v10, 4, v11
    v_add_u32 v3, s31, v3
    v_lshrrev_b32 v13, 5, v0
    v_bfe_u32 v10, v0, 3, 2
    v_bfe_u32 v11, v0, 1, 1
    v_lshl_or_b32 v10, v10, 1, v11
    v_bfe_u32 v11, v0, 2, 1
    v_cmp_eq_u32 vcc, v11, v13
    v_mov_b32 v12, 99
    s_nop 0
    v_cndmask_b32 v10, v12, v10, vcc
    v_and_b32 v11, 1, v0
    v_lshlrev_b32 v11, 4, v11
    v_mov_b32 v12, 0x3f80
    v_lshlrev_b32 v11, v11, v12
    v_cmp_eq_u32 s[76:77], 0, v10
    s_nop 1
    v_cndmask_b32 v208, 0, v11, s[76:77]
    v_cmp_eq_u32 s[78:79], 1, v10
    s_nop 1
    v_cndmask_b32 v209, 0, v11, s[78:79]
    v_cmp_eq_u32 s[80:81], 2, v10
    s_nop 1
    v_cndmask_b32 v210, 0, v11, s[80:81]
    v_cmp_eq_u32 s[82:83], 3, v10
    s_nop 1
    v_cndmask_b32 v211, 0, v11, s[82:83]
    v_cmp_eq_u32 s[76:77], 4, v10
    s_nop 1
    v_cndmask_b32 v212, 0, v11, s[76:77]
    v_cmp_eq_u32 s[78:79], 5, v10
    s_nop 1
    v_cndmask_b32 v213, 0, v11, s[78:79]
    v_cmp_eq_u32 s[80:81], 6, v10
    s_nop 1
    v_cndmask_b32 v214, 0, v11, s[80:81]
    v_cmp_eq_u32 s[82:83], 7, v10
    s_nop 1
    v_cndmask_b32 v215, 0, v11, s[82:83]
    s_bitcmp1_b32 0x87, s16
    s_cbranch_scc0 L_pV
    s_cmp_eq_u32 s16, 7
    s_mov_b32 s33, 49152
    s_cmov_b32 s33, 122880
    s_cselect_b32 s38, 3, 1
    s_cselect_b32 s39, 4, 0
    s_cselect_b32 s19, 16, 1
    v_mov_b32 v15, s19
    s_cmp_eq_u32 s32, 1
    s_cselect_b32 s28, 12288, 0
    s_cselect_b32 s29, 0, 12288
    s_cmp_eq_u32 s32, 2
    s_cselect_b32 s28, 24576, s28
    s_cselect_b32 s30, 0, 24576
    v_mov_b32 v216, 0x3f803f80
    v_mov_b32 v217, 0x3f803f80
    v_mov_b32 v218, 0x3f803f80
    v_mov_b32 v219, 0x3f803f80
    v_mov_b32 v221, 0
    v_mov_b32 v222, 0
    v_mov_b32 v223, 0
    v_mov_b32 v225, 0
    v_mov_b32 v226, 0
    v_mov_b32 v227, 0
    v_mov_b32 v229, 0
    v_mov_b32 v230, 0
    v_mov_b32 v231, 0
    v_and_b32 v10, 0x13, v0
    v_and_b32 v11, 4, v0
    v_and_b32 v12, 8, v0
    v_lshl_or_b32 v10, v11, 1, v10
    v_lshrrev_b32 v12, 1, v12
    v_or_b32 v10, v10, v12
    v_lshrrev_b32 v13, 5, v0
    v_bfe_u32 v11, v10, 1, 3
    v_xor_b32 v11, v11, v13
    v_mul_u32_u24 v10, 384, v10
    v_lshl_add_u32 v10, v11, 4, v10
    v_add_u32 v1, s33, v10
    v_xor_b32 v2, 32, v1
    v_xor_b32 v5, 64, v1
    v_xor_b32 v6, 0x60, v1
    s_cmp_eq_u32 s16, 7
    s_cbranch_scc1 L_M7
    s_waitcnt vmcnt(0)
    s_mov_b64 exec, 1
    ds_inc_u32 v4, v4 offset:40
    s_mov_b64 exec, -1
    s_setprio 2
    s_mov_b32 s19, 0x100000
L_Ml:
    ds_read_b32 v10, v4 offset:40
    s_sub_u32 s19, s19, 1
    s_cbranch_scc1 L_Ml_x
    s_waitcnt lgkmcnt(0)
    v_cmp_le_u32 vcc, 3, v10
    s_nop 0
    s_cbranch_vccz L_Ml
L_Ml_x:
    s_branch L_jM
L_M7:
    s_barrier
    s_mov_b32 s19, 0x100000
L_M7i:
    ds_read_b32 v10, v4 offset:56
    s_sub_u32 s19, s19, 1
    s_cbranch_scc1 L_M7i_x
    s_waitcnt lgkmcnt(0)
    v_cmp_le_u32 vcc, 2, v10
    s_nop 0
    s_cbranch_vccz L_M7i
L_M7i_x:
L_gl7:
    s_mov_b32 m0, s65
    s_add_u32 s65, s65, 3072
    buffer_load_dwordx4 v16, s[68:71], s64 offen offset:0 lds
    buffer_load_dwordx4 v17, s[68:71], s64 offen offset:1024 lds
    buffer_load_dwordx4 v18, s[68:71], s64 offen offset:2048 lds
    s_add_u32 s64, s64, 3072
    s_mov_b32 m0, s65
    s_add_u32 s65, s65, 3072
    buffer_load_dwordx4 v19, s[68:71], s64 offen offset:0 lds
    buffer_load_dwordx4 v20, s[68:71], s64 offen offset:1024 lds
    buffer_load_dwordx4 v21, s[68:71], s64 offen offset:2048 lds
    s_add_u32 s64, s64, 3072
    s_add_u32 s64, s64, s67
    s_sub_u32 s66, s66, 1
    s_cmp_lg_u32 s66, 0
    s_cbranch_scc1 L_gl7
    s_mov_b64 exec, 1
    ds_inc_u32 v4, v4 offset:56
    s_mov_b64 exec, -1
    s_mov_b64 exec, 1
    ds_inc_u32 v4, v4 offset:48
    s_mov_b64 exec, -1
    s_waitcnt vmcnt(0)
    s_setprio 1
L_jM:
    v_add_u32 v12, s28, v5
    ds_read_b128 v[16:19], v12 offset:128
    v_add_u32 v10, s28, v1
    v_add_u32 v13, s28, v6
    ds_read_b128 v[20:23], v13 offset:128
    ds_read_b128 v[24:27], v10 offset:256
    ds_read_b128 v[32:35], v12 offset:256
    v_add_u32 v11, s28, v2
    v_add_u32 v12, s29, v5
    ds_read_b128 v[28:31], v11 offset:256
    ds_read_b128 v[36:39], v13 offset:256
    ds_read_b128 v[40:43], v12 offset:128
    v_add_u32 v10, s29, v1
    v_add_u32 v13, s29, v6
    ds_read_b128 v[44:47], v13 offset:128
    ds_read_b128 v[48:51], v10 offset:256
    ds_read_b128 v[56:59], v12 offset:256
    v_add_u32 v11, s29, v2
    v_add_u32 v12, s30, v5
    ds_read_b128 v[52:55], v11 offset:256
    ds_read_b128 v[60:63], v13 offset:256
    ds_read_b128 v[64:67], v12 offset:128
    v_add_u32 v10, s30, v1
    v_add_u32 v13, s30, v6
    ds_read_b128 v[68:71], v13 offset:128
    ds_read_b128 v[72:75], v10 offset:256
    ds_read_b128 v[80:83], v12 offset:256
    v_add_u32 v11, s30, v2
    ds_read_b128 v[76:79], v11 offset:256
    ds_read_b128 v[84:87], v13 offset:256
    ds_read_b128 v[88:91], v1 offset:0
    ds_read_b128 v[112:115], v1 offset:12288
    ds_read_b128 v[136:139], v1 offset:24576
    ds_read_b128 v[92:95], v2 offset:0
    ds_read_b128 v[116:119], v2 offset:12288
    ds_read_b128 v[140:143], v2 offset:24576
    ds_read_b128 v[96:99], v5 offset:0
    ds_read_b128 v[120:123], v5 offset:12288
    ds_read_b128 v[144:147], v5 offset:24576
    ds_read_b128 v[100:103], v6 offset:0
    ds_read_b128 v[124:127], v6 offset:12288
    ds_read_b128 v[148:151], v6 offset:24576
    ds_read_b128 v[104:107], v1 offset:128
    ds_read_b128 v[128:131], v1 offset:12416
    ds_read_b128 v[152:155], v1 offset:24704
    ds_read_b128 v[108:111], v2 offset:128
    ds_read_b128 v[132:135], v2 offset:12416
    ds_read_b128 v[156:159], v2 offset:24704
    s_waitcnt lgkmcnt(15)
    v_mfma_f32_32x32x16_bf16 v[160:175], v[16:19], v[208:211], 0
    v_mfma_f32_32x32x16_bf16 v[160:175], v[20:23], v[212:215], v[160:175]
    v_mfma_f32_32x32x16_bf16 v[176:191], v[24:27], v[208:211], 0
    v_mfma_f32_32x32x16_bf16 v[192:207], v[32:35], v[208:211], 0
    v_mfma_f32_32x32x16_bf16 v[160:175], v[40:43], v[208:211], v[160:175]
    v_mfma_f32_32x32x16_bf16 v[176:191], v[28:31], v[212:215], v[176:191]
    s_waitcnt lgkmcnt(0)
    s_mov_b64 exec, 1
    ds_add_u32 v14, v15
    s_mov_b64 exec, -1
    v_mfma_f32_32x32x16_bf16 v[192:207], v[36:39], v[212:215], v[192:207]
    v_mfma_f32_32x32x16_bf16 v[160:175], v[44:47], v[212:215], v[160:175]
    v_mfma_f32_32x32x16_bf16 v[176:191], v[48:51], v[208:211], v[176:191]
    v_mfma_f32_32x32x16_bf16 v[192:207], v[56:59], v[208:211], v[192:207]
    v_mfma_f32_32x32x16_bf16 v[160:175], v[64:67], v[208:211], v[160:175]
    v_mfma_f32_32x32x16_bf16 v[176:191], v[52:55], v[212:215], v[176:191]
    v_mfma_f32_32x32x16_bf16 v[192:207], v[60:63], v[212:215], v[192:207]
    v_mfma_f32_32x32x16_bf16 v[160:175], v[68:71], v[212:215], v[160:175]
    v_mfma_f32_32x32x16_bf16 v[176:191], v[72:75], v[208:211], v[176:191]
    s_nop 3
    v_add_f32 v160, v160, v161
    v_mfma_f32_32x32x16_bf16 v[192:207], v[80:83], v[208:211], v[192:207]
    v_add_f32 v162, v162, v163
    v_add_f32 v164, v164, v165
    v_add_f32 v166, v166, v167
    v_add_f32 v168, v168, v169
    v_add_f32 v170, v170, v171
    v_add_f32 v172, v172, v173
    v_mfma_f32_32x32x16_bf16 v[176:191], v[76:79], v[212:215], v[176:191]
    v_add_f32 v174, v174, v175
    v_add_f32 v160, v160, v162
    v_add_f32 v164, v164, v166
    v_add_f32 v168, v168, v170
    v_add_f32 v172, v172, v174
    v_add_f32 v160, v160, v164
    v_mfma_f32_32x32x16_bf16 v[192:207], v[84:87], v[212:215], v[192:207]
    v_add_f32 v168, v168, v172
    v_add_f32 v10, v160, v168
    v_mul_f32 v10, 0xbc2aaaab, v10
    v_cvt_pk_bf16_f32 v220, v10, 0
    v_add_f32 v176, v176, v177
    v_add_f32 v178, v178, v179
    v_mfma_f32_32x32x16_bf16 v[160:175], v[220:223], v[216:219], 0
    v_add_f32 v180, v180, v181
    v_add_f32 v182, v182, v183
    v_add_f32 v184, v184, v185
    v_add_f32 v186, v186, v187
    v_add_f32 v188, v188, v189
    v_add_f32 v190, v190, v191
    v_add_f32 v192, v192, v193
    v_add_f32 v194, v194, v195
    v_add_f32 v196, v196, v197
    v_add_f32 v198, v198, v199
    v_add_f32 v200, v200, v201
    v_add_f32 v202, v202, v203
    v_add_f32 v204, v204, v205
    v_add_f32 v206, v206, v207
    v_add_f32 v176, v176, v178
    v_add_f32 v180, v180, v182
    v_add_f32 v184, v184, v186
    v_add_f32 v188, v188, v190
    v_add_f32 v192, v192, v194
    v_add_f32 v196, v196, v198
    v_add_f32 v200, v200, v202
    v_add_f32 v204, v204, v206
    v_add_f32 v176, v176, v180
    v_add_f32 v184, v184, v188
    v_add_f32 v192, v192, v196
    v_add_f32 v200, v200, v204
    v_add_f32 v11, v176, v184
    v_add_f32 v12, v192, v200
    v_mul_f32 v11, 0xbc2aaaab, v11
    v_mul_f32 v12, 0xbc2aaaab, v12
    v_cvt_pk_bf16_f32 v224, v11, 0
    v_cvt_pk_bf16_f32 v228, v12, 0
    v_cvt_pk_bf16_f32 v160, v160, v161
    v_mfma_f32_32x32x16_bf16 v[176:191], v[224:227], v[216:219], 0
    v_cvt_pk_bf16_f32 v161, v162, v163
    v_cvt_pk_bf16_f32 v162, v164, v165
    v_cvt_pk_bf16_f32 v163, v166, v167
    v_cvt_pk_bf16_f32 v164, v168, v169
    v_cvt_pk_bf16_f32 v165, v170, v171
    v_cvt_pk_bf16_f32 v166, v172, v173
    v_mfma_f32_32x32x16_bf16 v[192:207], v[228:231], v[216:219], 0
    v_cvt_pk_bf16_f32 v167, v174, v175
    s_nop 2
    v_cvt_pk_bf16_f32 v176, v176, v177
    v_mfma_f32_32x32x16_bf16 v[208:223], v[88:91], v[160:163], 0
    v_cvt_pk_bf16_f32 v177, v178, v179
    v_cvt_pk_bf16_f32 v178, v180, v181
    v_cvt_pk_bf16_f32 v179, v182, v183
    v_cvt_pk_bf16_f32 v180, v184, v185
    v_cvt_pk_bf16_f32 v181, v186, v187
    v_cvt_pk_bf16_f32 v182, v188, v189
    v_mfma_f32_32x32x16_bf16 v[240:255], v[136:139], v[160:163], 0
    v_cvt_pk_bf16_f32 v183, v190, v191
    v_cvt_pk_bf16_f32 v192, v192, v193
    v_cvt_pk_bf16_f32 v193, v194, v195
    v_cvt_pk_bf16_f32 v194, v196, v197
    v_cvt_pk_bf16_f32 v195, v198, v199
    v_cvt_pk_bf16_f32 v196, v200, v201
    v_mfma_f32_32x32x16_bf16 v[224:239], v[112:115], v[160:163], 0
    v_cvt_pk_bf16_f32 v197, v202, v203
    v_cvt_pk_bf16_f32 v198, v204, v205
    v_cvt_pk_bf16_f32 v199, v206, v207
    v_mfma_f32_32x32x16_bf16 v[208:223], v[92:95], v[164:167], v[208:223]
    v_mfma_f32_32x32x16_bf16 v[240:255], v[140:143], v[164:167], v[240:255]
    v_mfma_f32_32x32x16_bf16 v[224:239], v[116:119], v[164:167], v[224:239]
    v_mfma_f32_32x32x16_bf16 v[208:223], v[96:99], v[176:179], v[208:223]
    v_mfma_f32_32x32x16_bf16 v[240:255], v[144:147], v[176:179], v[240:255]
    v_mfma_f32_32x32x16_bf16 v[224:239], v[120:123], v[176:179], v[224:239]
    v_mfma_f32_32x32x16_bf16 v[208:223], v[100:103], v[180:183], v[208:223]
    v_mfma_f32_32x32x16_bf16 v[240:255], v[148:151], v[180:183], v[240:255]
    v_mfma_f32_32x32x16_bf16 v[224:239], v[124:127], v[180:183], v[224:239]
    v_mfma_f32_32x32x16_bf16 v[208:223], v[104:107], v[192:195], v[208:223]
    v_mfma_f32_32x32x16_bf16 v[240:255], v[152:155], v[192:195], v[240:255]
    v_mfma_f32_32x32x16_bf16 v[224:239], v[128:131], v[192:195], v[224:239]
    v_mfma_f32_32x32x16_bf16 v[208:223], v[108:111], v[196:199], v[208:223]
    v_mfma_f32_32x32x16_bf16 v[240:255], v[156:159], v[196:199], v[240:255]
    v_mfma_f32_32x32x16_bf16 v[224:239], v[132:135], v[196:199], v[224:239]
    s_cmp_eq_u32 s16, 7
    s_mov_b32 s64, 15
    s_cselect_b32 s65, 0, 6
L_jMl:
    s_nop 15
    v_mfma_f32_32x32x16_bf16 v[160:175], v[88:91], v[16:19], v[208:223]
    v_mfma_f32_32x32x16_bf16 v[176:191], v[112:115], v[16:19], v[224:239]
    v_mfma_f32_32x32x16_bf16 v[192:207], v[136:139], v[16:19], v[240:255]
    ds_read_b32 v16, v4 offset:24
    v_mfma_f32_32x32x16_bf16 v[160:175], v[92:95], v[20:23], v[160:175]
    v_mfma_f32_32x32x16_bf16 v[176:191], v[116:119], v[20:23], v[176:191]
    v_mfma_f32_32x32x16_bf16 v[192:207], v[140:143], v[20:23], v[192:207]
    v_mfma_f32_32x32x16_bf16 v[160:175], v[96:99], v[24:27], v[160:175]
    s_waitcnt lgkmcnt(0)
    v_and_b32 v16, s64, v16
    v_cmp_le_u32 vcc, s65, v16
    s_nop 0
    s_cbranch_vccz L_Mc_slow
L_Mc_back:
    v_mfma_f32_32x32x16_bf16 v[176:191], v[120:123], v[24:27], v[176:191]
    v_mfma_f32_32x32x16_bf16 v[192:207], v[144:147], v[24:27], v[192:207]
    v_mfma_f32_32x32x16_bf16 v[160:175], v[100:103], v[28:31], v[160:175]
    v_mfma_f32_32x32x16_bf16 v[176:191], v[124:127], v[28:31], v[176:191]
    v_mfma_f32_32x32x16_bf16 v[192:207], v[148:151], v[28:31], v[192:207]
    v_mfma_f32_32x32x16_bf16 v[160:175], v[104:107], v[32:35], v[160:175]
    v_mfma_f32_32x32x16_bf16 v[176:191], v[128:131], v[32:35], v[176:191]
    v_mfma_f32_32x32x16_bf16 v[192:207], v[152:155], v[32:35], v[192:207]
    v_mfma_f32_32x32x16_bf16 v[160:175], v[108:111], v[36:39], v[160:175]
    v_mfma_f32_32x32x16_bf16 v[176:191], v[132:135], v[36:39], v[176:191]
    s_nop 3
    v_add_f32 v10, v160, v164
    v_mfma_f32_32x32x16_bf16 v[192:207], v[156:159], v[36:39], v[192:207]
    v_add_f32 v11, v161, v165
    v_add_f32 v12, v162, v166
    v_add_f32 v13, v163, v167
    v_add_f32 v10, v10, v168
    v_add_f32 v11, v11, v169
    v_add_f32 v12, v12, v170
    v_add_f32 v13, v13, v171
    v_add_f32 v10, v10, v172
    v_add_f32 v11, v11, v173
    v_add_f32 v12, v12, v174
    v_add_f32 v13, v13, v175
    v_add_f32 v10, v10, v176
    v_add_f32 v11, v11, v177
    v_add_f32 v12, v12, v178
    v_add_f32 v13, v13, v179
    v_add_f32 v10, v10, v180
    v_add_f32 v11, v11, v181
    v_add_f32 v12, v12, v182
    v_add_f32 v13, v13, v183
    v_add_f32 v10, v10, v184
    v_add_f32 v11, v11, v185
    v_add_f32 v12, v12, v186
    v_add_f32 v13, v13, v187
    v_add_f32 v10, v10, v188
    v_add_f32 v11, v11, v189
    v_add_f32 v12, v12, v190
    v_add_f32 v13, v13, v191
    v_add_f32 v10, v10, v192
    v_add_f32 v11, v11, v193
    v_add_f32 v12, v12, v194
    v_add_f32 v13, v13, v195
    v_add_f32 v10, v10, v196
    v_add_f32 v11, v11, v197
    v_add_f32 v12, v12, v198
    v_add_f32 v13, v13, v199
    v_add_f32 v10, v10, v200
    v_add_f32 v11, v11, v201
    v_add_f32 v12, v12, v202
    v_add_f32 v13, v13, v203
    v_add_f32 v10, v10, v204
    v_add_f32 v11, v11, v205
    v_add_f32 v12, v12, v206
    v_add_f32 v13, v13, v207
    v_add_f32 v10, v10, v12
    v_add_f32 v11, v11, v13
    v_add_f32 v10, v10, v11
    v_mov_b32 v11, v10
    v_mov_b32 v12, 0x3e16c740
    s_nop 0
    v_permlane32_swap_b32 v10, v11
    v_add_f32 v10, v10, v11
    v_mul_f32 v10, 0xbac909aa, v10
    v_fma_f32 v160, v160, v12, v10
    v_fma_f32 v161, v161, v12, v10
    v_fma_f32 v176, v176, v12, v10
    v_fma_f32 v177, v177, v12, v10
    v_fma_f32 v192, v192, v12, v10
    v_fma_f32 v193, v193, v12, v10
    v_fma_f32 v162, v162, v12, v10
    v_fma_f32 v163, v163, v12, v10
    v_cvt_pk_bf16_f32 v160, v160, v161
    v_fma_f32 v178, v178, v12, v10
    v_fma_f32 v179, v179, v12, v10
    v_cvt_pk_bf16_f32 v176, v176, v177
    v_fma_f32 v194, v194, v12, v10
    v_fma_f32 v195, v195, v12, v10
    v_cvt_pk_bf16_f32 v192, v192, v193
    v_fma_f32 v164, v164, v12, v10
    v_fma_f32 v165, v165, v12, v10
    v_fma_f32 v166, v166, v12, v10
    v_fma_f32 v167, v167, v12, v10
    v_cvt_pk_bf16_f32 v161, v162, v163
    v_fma_f32 v180, v180, v12, v10
    v_fma_f32 v181, v181, v12, v10
    v_fma_f32 v182, v182, v12, v10
    v_fma_f32 v183, v183, v12, v10
    v_cvt_pk_bf16_f32 v177, v178, v179
    v_fma_f32 v196, v196, v12, v10
    v_fma_f32 v197, v197, v12, v10
    v_fma_f32 v198, v198, v12, v10
    v_fma_f32 v199, v199, v12, v10
    v_cvt_pk_bf16_f32 v193, v194, v195
    v_fma_f32 v168, v168, v12, v10
    v_fma_f32 v169, v169, v12, v10
    v_fma_f32 v170, v170, v12, v10
    v_fma_f32 v171, v171, v12, v10
    v_fma_f32 v172, v172, v12, v10
    v_fma_f32 v173, v173, v12, v10
    v_fma_f32 v174, v174, v12, v10
    v_fma_f32 v175, v175, v12, v10
    v_cvt_pk_bf16_f32 v162, v164, v165
    v_cvt_pk_bf16_f32 v163, v166, v167
    v_fma_f32 v184, v184, v12, v10
    v_fma_f32 v185, v185, v12, v10
    v_fma_f32 v186, v186, v12, v10
    v_fma_f32 v187, v187, v12, v10
    v_fma_f32 v188, v188, v12, v10
    v_fma_f32 v189, v189, v12, v10
    v_fma_f32 v190, v190, v12, v10
    v_fma_f32 v191, v191, v12, v10
    v_cvt_pk_bf16_f32 v178, v180, v181
    v_cvt_pk_bf16_f32 v179, v182, v183
    v_fma_f32 v200, v200, v12, v10
    v_fma_f32 v201, v201, v12, v10
    v_fma_f32 v202, v202, v12, v10
    v_fma_f32 v203, v203, v12, v10
    v_fma_f32 v204, v204, v12, v10
    v_fma_f32 v205, v205, v12, v10
    v_fma_f32 v206, v206, v12, v10
    v_fma_f32 v207, v207, v12, v10
    v_cvt_pk_bf16_f32 v194, v196, v197
    v_cvt_pk_bf16_f32 v195, v198, v199
    v_cvt_pk_bf16_f32 v164, v168, v169
    v_cvt_pk_bf16_f32 v165, v170, v171
    v_cvt_pk_bf16_f32 v166, v172, v173
    v_cvt_pk_bf16_f32 v167, v174, v175
    v_cvt_pk_bf16_f32 v180, v184, v185
    v_cvt_pk_bf16_f32 v181, v186, v187
    v_cvt_pk_bf16_f32 v182, v188, v189
    v_cvt_pk_bf16_f32 v183, v190, v191
    v_cvt_pk_bf16_f32 v196, v200, v201
    v_cvt_pk_bf16_f32 v197, v202, v203
    v_cvt_pk_bf16_f32 v198, v204, v205
    v_cvt_pk_bf16_f32 v199, v206, v207
    ds_write_b128 v3, v[160:163] offset:0
    ds_write_b128 v3, v[164:167] offset:512
    ds_write_b128 v3, v[176:179] offset:1024
    ds_write_b128 v3, v[180:183] offset:1536
    ds_write_b128 v3, v[192:195] offset:2048
    ds_write_b128 v3, v[196:199] offset:2560
    s_sub_u32 s38, s38, 1
    s_cmp_eq_u32 s38, 0
    s_cbranch_scc1 L_jd
    v_mov_b32 v16, v40
    v_mov_b32 v17, v41
    v_mov_b32 v18, v42
    v_mov_b32 v19, v43
    v_mov_b32 v20, v44
    v_mov_b32 v21, v45
    v_mov_b32 v22, v46
    v_mov_b32 v23, v47
    v_mov_b32 v24, v48
    v_mov_b32 v25, v49
    v_mov_b32 v26, v50
    v_mov_b32 v27, v51
    v_mov_b32 v28, v52
    v_mov_b32 v29, v53
    v_mov_b32 v30, v54
    v_mov_b32 v31, v55
    v_mov_b32 v32, v56
    v_mov_b32 v33, v57
    v_mov_b32 v34, v58
    v_mov_b32 v35, v59
    v_mov_b32 v36, v60
    v_mov_b32 v37, v61
    v_mov_b32 v38, v62
    v_mov_b32 v39, v63
    v_mov_b32 v40, v64
    v_mov_b32 v41, v65
    v_mov_b32 v42, v66
    v_mov_b32 v43, v67
    v_mov_b32 v44, v68
    v_mov_b32 v45, v69
    v_mov_b32 v46, v70
    v_mov_b32 v47, v71
    v_mov_b32 v48, v72
    v_mov_b32 v49, v73
    v_mov_b32 v50, v74
    v_mov_b32 v51, v75
    v_mov_b32 v52, v76
    v_mov_b32 v53, v77
    v_mov_b32 v54, v78
    v_mov_b32 v55, v79
    v_mov_b32 v56, v80
    v_mov_b32 v57, v81
    v_mov_b32 v58, v82
    v_mov_b32 v59, v83
    v_mov_b32 v60, v84
    v_mov_b32 v61, v85
    v_mov_b32 v62, v86
    v_mov_b32 v63, v87
    v_add_u32 v3, 6144, v3
    s_branch L_jMl
L_pV:
    s_mov_b32 s33, 86016
    v_mov_b32 v15, 1
    v_and_b32 v10, 0x13, v0
    v_and_b32 v11, 4, v0
    v_and_b32 v12, 8, v0
    v_lshl_or_b32 v10, v11, 1, v10
    v_lshrrev_b32 v12, 1, v12
    v_or_b32 v10, v10, v12
    v_lshrrev_b32 v13, 5, v0
    v_bfe_u32 v11, v10, 2, 2
    v_xor_b32 v11, v11, v13
    v_mul_u32_u24 v10, 192, v10
    v_lshl_add_u32 v10, v11, 4, v10
    v_add_u32 v1, s33, v10
    v_xor_b32 v2, 32, v1
    s_lshl_b32 s19, s32, 6
    v_add_u32 v5, s19, v1
    v_add_u32 v6, s19, v2
    s_barrier
    s_cmp_eq_u32 s16, 5
    s_cbranch_scc1 L_V5
L_gl3:
    s_mov_b32 m0, s65
    s_add_u32 s65, s65, 3072
    buffer_load_dwordx4 v16, s[68:71], s64 offen offset:0 lds
    buffer_load_dwordx4 v17, s[68:71], s64 offen offset:1024 lds
    buffer_load_dwordx4 v18, s[68:71], s64 offen offset:2048 lds
    s_add_u32 s64, s64, 3072
    s_mov_b32 m0, s65
    s_add_u32 s65, s65, 3072
    buffer_load_dwordx4 v19, s[68:71], s64 offen offset:0 lds
    buffer_load_dwordx4 v20, s[68:71], s64 offen offset:1024 lds
    buffer_load_dwordx4 v21, s[68:71], s64 offen offset:2048 lds
    s_add_u32 s64, s64, 3072
    s_add_u32 s64, s64, s67
    s_sub_u32 s66, s66, 1
    s_cmp_lg_u32 s66, 0
    s_cbranch_scc1 L_gl3
    s_mov_b64 exec, 1
    ds_inc_u32 v4, v4 offset:56
    s_mov_b64 exec, -1
    s_waitcnt vmcnt(0)
    s_mov_b64 exec, 1
    ds_inc_u32 v4, v4 offset:28
    s_mov_b64 exec, -1
L_V5:
    s_mov_b32 s64, 15
    s_mov_b32 s65, 6
    s_setprio 2
    s_mov_b32 s19, 0x100000
L_Vl:
    ds_read_b32 v10, v4 offset:28
    s_sub_u32 s19, s19, 1
    s_cbranch_scc1 L_Vl_x
    s_waitcnt lgkmcnt(0)
    v_cmp_le_u32 vcc, 2, v10
    s_nop 0
    s_cbranch_vccz L_Vl
L_Vl_x:
L_jV:
    ds_read_b128 v[16:19], v5 offset:18432
    ds_read_b128 v[24:27], v5 offset:24576
    ds_read_b128 v[32:35], v5 offset:30720
    ds_read_b128 v[20:23], v6 offset:18432
    ds_read_b128 v[28:31], v6 offset:24576
    ds_read_b128 v[36:39], v6 offset:30720
    ds_read_b128 v[88:91], v1 offset:0
    ds_read_b128 v[112:115], v1 offset:6144
    ds_read_b128 v[136:139], v1 offset:12288
    ds_read_b128 v[92:95], v2 offset:0
    ds_read_b128 v[116:119], v2 offset:6144
    ds_read_b128 v[140:143], v2 offset:12288
    ds_read_b128 v[96:99], v1 offset:64
    ds_read_b128 v[100:103], v2 offset:64
    ds_read_b128 v[104:107], v1 offset:128
    ds_read_b128 v[108:111], v2 offset:128
    ds_read_b128 v[120:123], v1 offset:6208
    ds_read_b128 v[124:127], v2 offset:6208
    ds_read_b128 v[128:131], v1 offset:6272
    ds_read_b128 v[132:135], v2 offset:6272
    ds_read_b128 v[144:147], v1 offset:12352
    ds_read_b128 v[148:151], v2 offset:12352
    ds_read_b128 v[152:155], v1 offset:12416
    ds_read_b128 v[156:159], v2 offset:12416
    s_waitcnt lgkmcnt(15)
    v_mfma_f32_32x32x16_bf16 v[160:175], v[16:19], v[208:211], 0
    v_mfma_f32_32x32x16_bf16 v[176:191], v[24:27], v[208:211], 0
    v_mfma_f32_32x32x16_bf16 v[192:207], v[32:35], v[208:211], 0
    s_waitcnt lgkmcnt(0)
    s_mov_b64 exec, 1
    ds_add_u32 v14, v15
    s_mov_b64 exec, -1
    v_mfma_f32_32x32x16_bf16 v[160:175], v[20:23], v[212:215], v[160:175]
    ds_read_b32 v16, v4 offset:24
    v_mfma_f32_32x32x16_bf16 v[176:191], v[28:31], v[212:215], v[176:191]
    s_nop 3
    v_cvt_pk_bf16_f32 v216, v160, v161
    v_mfma_f32_32x32x16_bf16 v[192:207], v[36:39], v[212:215], v[192:207]
    v_cvt_pk_bf16_f32 v217, v162, v163
    v_cvt_pk_bf16_f32 v218, v164, v165
    v_cvt_pk_bf16_f32 v219, v166, v167
    v_cvt_pk_bf16_f32 v220, v168, v169
    v_cvt_pk_bf16_f32 v221, v170, v171
    v_cvt_pk_bf16_f32 v222, v172, v173
    v_cvt_pk_bf16_f32 v223, v174, v175
    v_mfma_f32_32x32x16_bf16 v[160:175], v[88:91], v[216:219], 0
    v_cvt_pk_bf16_f32 v224, v176, v177
    v_cvt_pk_bf16_f32 v225, v178, v179
    v_cvt_pk_bf16_f32 v226, v180, v181
    v_cvt_pk_bf16_f32 v227, v182, v183
    v_cvt_pk_bf16_f32 v228, v184, v185
    v_cvt_pk_bf16_f32 v229, v186, v187
    v_mfma_f32_32x32x16_bf16 v[160:175], v[92:95], v[220:223], v[160:175]
    v_cvt_pk_bf16_f32 v230, v188, v189
    v_cvt_pk_bf16_f32 v231, v190, v191
    v_cvt_pk_bf16_f32 v232, v192, v193
    v_cvt_pk_bf16_f32 v233, v194, v195
    v_cvt_pk_bf16_f32 v234, v196, v197
    v_cvt_pk_bf16_f32 v235, v198, v199
    v_mfma_f32_32x32x16_bf16 v[176:191], v[112:115], v[216:219], 0
    v_cvt_pk_bf16_f32 v236, v200, v201
    v_cvt_pk_bf16_f32 v237, v202, v203
    v_cvt_pk_bf16_f32 v238, v204, v205
    v_cvt_pk_bf16_f32 v239, v206, v207
    v_mfma_f32_32x32x16_bf16 v[192:207], v[136:139], v[216:219], 0
    s_waitcnt lgkmcnt(0)
    v_and_b32 v16, s64, v16
    v_cmp_le_u32 vcc, s65, v16
    s_nop 0
    s_cbranch_vccz L_Vc_slow
L_Vc_back:
    v_mfma_f32_32x32x16_bf16 v[176:191], v[116:119], v[220:223], v[176:191]
    v_mfma_f32_32x32x16_bf16 v[192:207], v[140:143], v[220:223], v[192:207]
    v_mfma_f32_32x32x16_bf16 v[160:175], v[96:99], v[224:227], v[160:175]
    v_mfma_f32_32x32x16_bf16 v[176:191], v[120:123], v[224:227], v[176:191]
    v_mfma_f32_32x32x16_bf16 v[192:207], v[144:147], v[224:227], v[192:207]
    v_mfma_f32_32x32x16_bf16 v[160:175], v[100:103], v[228:231], v[160:175]
    v_mfma_f32_32x32x16_bf16 v[176:191], v[124:127], v[228:231], v[176:191]
    v_mfma_f32_32x32x16_bf16 v[192:207], v[148:151], v[228:231], v[192:207]
    v_mfma_f32_32x32x16_bf16 v[160:175], v[104:107], v[232:235], v[160:175]
    v_mfma_f32_32x32x16_bf16 v[176:191], v[128:131], v[232:235], v[176:191]
    v_mfma_f32_32x32x16_bf16 v[192:207], v[152:155], v[232:235], v[192:207]
    v_mfma_f32_32x32x16_bf16 v[160:175], v[108:111], v[236:239], v[160:175]
    v_mfma_f32_32x32x16_bf16 v[176:191], v[132:135], v[236:239], v[176:191]
    s_nop 3
    v_add_f32 v10, v160, v164
    v_mfma_f32_32x32x16_bf16 v[192:207], v[156:159], v[236:239], v[192:207]
    v_add_f32 v11, v161, v165
    v_add_f32 v12, v162, v166
    v_add_f32 v13, v163, v167
    v_add_f32 v10, v10, v168
    v_add_f32 v11, v11, v169
    v_add_f32 v12, v12, v170
    v_add_f32 v13, v13, v171
    v_add_f32 v10, v10, v172
    v_add_f32 v11, v11, v173
    v_add_f32 v12, v12, v174
    v_add_f32 v13, v13, v175
    v_add_f32 v10, v10, v176
    v_add_f32 v11, v11, v177
    v_add_f32 v12, v12, v178
    v_add_f32 v13, v13, v179
    v_add_f32 v10, v10, v180
    v_add_f32 v11, v11, v181
    v_add_f32 v12, v12, v182
    v_add_f32 v13, v13, v183
    v_add_f32 v10, v10, v184
    v_add_f32 v11, v11, v185
    v_add_f32 v12, v12, v186
    v_add_f32 v13, v13, v187
    v_add_f32 v10, v10, v188
    v_add_f32 v11, v11, v189
    v_add_f32 v12, v12, v190
    v_add_f32 v13, v13, v191
    v_add_f32 v10, v10, v192
    v_add_f32 v11, v11, v193
    v_add_f32 v12, v12, v194
    v_add_f32 v13, v13, v195
    v_add_f32 v10, v10, v196
    v_add_f32 v11, v11, v197
    v_add_f32 v12, v12, v198
    v_add_f32 v13, v13, v199
    v_add_f32 v10, v10, v200
    v_add_f32 v11, v11, v201
    v_add_f32 v12, v12, v202
    v_add_f32 v13, v13, v203
    v_add_f32 v10, v10, v204
    v_add_f32 v11, v11, v205
    v_add_f32 v12, v12, v206
    v_add_f32 v13, v13, v207
    v_add_f32 v10, v10, v12
    v_add_f32 v11, v11, v13
    v_add_f32 v10, v10, v11
    v_mov_b32 v11, v10
    v_mov_b32 v12, 0x3f800000
    s_nop 0
    v_permlane32_swap_b32 v10, v11
    v_add_f32 v10, v10, v11
    v_mul_f32 v10, 0xbc2aaaab, v10
    v_fma_f32 v160, v160, v12, v10
    v_fma_f32 v161, v161, v12, v10
    v_fma_f32 v176, v176, v12, v10
    v_fma_f32 v177, v177, v12, v10
    v_fma_f32 v192, v192, v12, v10
    v_fma_f32 v193, v193, v12, v10
    v_fma_f32 v162, v162, v12, v10
    v_fma_f32 v163, v163, v12, v10
    v_cvt_pk_bf16_f32 v160, v160, v161
    v_fma_f32 v178, v178, v12, v10
    v_fma_f32 v179, v179, v12, v10
    v_cvt_pk_bf16_f32 v176, v176, v177
    v_fma_f32 v194, v194, v12, v10
    v_fma_f32 v195, v195, v12, v10
    v_cvt_pk_bf16_f32 v192, v192, v193
    v_fma_f32 v164, v164, v12, v10
    v_fma_f32 v165, v165, v12, v10
    v_fma_f32 v166, v166, v12, v10
    v_fma_f32 v167, v167, v12, v10
    v_cvt_pk_bf16_f32 v161, v162, v163
    v_fma_f32 v180, v180, v12, v10
    v_fma_f32 v181, v181, v12, v10
    v_fma_f32 v182, v182, v12, v10
    v_fma_f32 v183, v183, v12, v10
    v_cvt_pk_bf16_f32 v177, v178, v179
    v_fma_f32 v196, v196, v12, v10
    v_fma_f32 v197, v197, v12, v10
    v_fma_f32 v198, v198, v12, v10
    v_fma_f32 v199, v199, v12, v10
    v_cvt_pk_bf16_f32 v193, v194, v195
    v_fma_f32 v168, v168, v12, v10
    v_fma_f32 v169, v169, v12, v10
    v_fma_f32 v170, v170, v12, v10
    v_fma_f32 v171, v171, v12, v10
    v_fma_f32 v172, v172, v12, v10
    v_fma_f32 v173, v173, v12, v10
    v_fma_f32 v174, v174, v12, v10
    v_fma_f32 v175, v175, v12, v10
    v_cvt_pk_bf16_f32 v162, v164, v165
    v_cvt_pk_bf16_f32 v163, v166, v167
    v_fma_f32 v184, v184, v12, v10
    v_fma_f32 v185, v185, v12, v10
    v_fma_f32 v186, v186, v12, v10
    v_fma_f32 v187, v187, v12, v10
    v_fma_f32 v188, v188, v12, v10
    v_fma_f32 v189, v189, v12, v10
    v_fma_f32 v190, v190, v12, v10
    v_fma_f32 v191, v191, v12, v10
    v_cvt_pk_bf16_f32 v178, v180, v181
    v_cvt_pk_bf16_f32 v179, v182, v183
    v_fma_f32 v200, v200, v12, v10
    v_fma_f32 v201, v201, v12, v10
    v_fma_f32 v202, v202, v12, v10
    v_fma_f32 v203, v203, v12, v10
    v_fma_f32 v204, v204, v12, v10
    v_fma_f32 v205, v205, v12, v10
    v_fma_f32 v206, v206, v12, v10
    v_fma_f32 v207, v207, v12, v10
    v_cvt_pk_bf16_f32 v194, v196, v197
    v_cvt_pk_bf16_f32 v195, v198, v199
    v_cvt_pk_bf16_f32 v164, v168, v169
    v_cvt_pk_bf16_f32 v165, v170, v171
    v_cvt_pk_bf16_f32 v166, v172, v173
    v_cvt_pk_bf16_f32 v167, v174, v175
    v_cvt_pk_bf16_f32 v180, v184, v185
    v_cvt_pk_bf16_f32 v181, v186, v187
    v_cvt_pk_bf16_f32 v182, v188, v189
    v_cvt_pk_bf16_f32 v183, v190, v191
    v_cvt_pk_bf16_f32 v196, v200, v201
    v_cvt_pk_bf16_f32 v197, v202, v203
    v_cvt_pk_bf16_f32 v198, v204, v205
    v_cvt_pk_bf16_f32 v199, v206, v207
    ds_write_b128 v3, v[160:163] offset:0
    ds_write_b128 v3, v[164:167] offset:512
    ds_write_b128 v3, v[176:179] offset:1024
    ds_write_b128 v3, v[180:183] offset:1536
    ds_write_b128 v3, v[192:195] offset:2048
    ds_write_b128 v3, v[196:199] offset:2560
L_jd:
    v_add_u32 v10, s39, v4
    s_mov_b64 exec, 1
    ds_inc_u32 v10, v10 offset:8
    s_mov_b64 exec, -1
    s_cmp_lt_u32 s16, 4
    s_cbranch_scc1 L_T
    s_cmp_eq_u32 s39, 4
    s_cbranch_scc1 L_S
    s_setprio 0
    s_cmp_eq_u32 s16, 4
    s_mov_b32 s60, 5462
    s_cselect_b32 s64, 0, 384
    s_mov_b32 s65, 61440
    s_cmov_b32 s65, 79872
    s_mov_b32 s66, 3
    s_cselect_b32 s68, s26, s24
    s_cselect_b32 s69, s27, s25
    s_and_b32 s69, s69, 0xffff
    s_mov_b32 s71, 0x20000
    v_mul_u32_u24 v10, s60, v0
    v_lshlrev_b32 v11, 4, v0
    s_lshl_b32 s60, s60, 6
    v_lshrrev_b32 v12, s61, v10
    v_lshrrev_b32 v13, 16, v10
    v_and_b32 v12, s62, v12
    v_xor_b32 v12, v12, v11
    v_mad_u32_u24 v16, v13, s63, v12
    v_add_u32 v10, s60, v10
    v_lshrrev_b32 v12, s61, v10
    v_lshrrev_b32 v13, 16, v10
    v_and_b32 v12, s62, v12
    v_xor_b32 v12, v12, v11
    v_mad_u32_u24 v17, v13, s63, v12
    v_add_u32 v10, s60, v10
    v_lshrrev_b32 v12, s61, v10
    v_lshrrev_b32 v13, 16, v10
    v_and_b32 v12, s62, v12
    v_xor_b32 v12, v12, v11
    v_mad_u32_u24 v18, v13, s63, v12
    v_add_u32 v10, s60, v10
    v_lshrrev_b32 v12, s61, v10
    v_lshrrev_b32 v13, 16, v10
    v_and_b32 v12, s62, v12
    v_xor_b32 v12, v12, v11
    v_mad_u32_u24 v19, v13, s63, v12
    v_add_u32 v10, s60, v10
    v_lshrrev_b32 v12, s61, v10
    v_lshrrev_b32 v13, 16, v10
    v_and_b32 v12, s62, v12
    v_xor_b32 v12, v12, v11
    v_mad_u32_u24 v20, v13, s63, v12
    v_add_u32 v10, s60, v10
    v_lshrrev_b32 v12, s61, v10
    v_lshrrev_b32 v13, 16, v10
    v_and_b32 v12, s62, v12
    v_xor_b32 v12, v12, v11
    v_mad_u32_u24 v21, v13, s63, v12
L_gl4:
    s_mov_b32 m0, s65
    s_add_u32 s65, s65, 3072
    buffer_load_dwordx4 v16, s[68:71], s64 offen offset:0 lds
    buffer_load_dwordx4 v17, s[68:71], s64 offen offset:1024 lds
    buffer_load_dwordx4 v18, s[68:71], s64 offen offset:2048 lds
    s_add_u32 s64, s64, 3072
    s_mov_b32 m0, s65
    s_add_u32 s65, s65, 3072
    buffer_load_dwordx4 v19, s[68:71], s64 offen offset:0 lds
    buffer_load_dwordx4 v20, s[68:71], s64 offen offset:1024 lds
    buffer_load_dwordx4 v21, s[68:71], s64 offen offset:2048 lds
    s_add_u32 s64, s64, 3072
    s_add_u32 s64, s64, s67
    s_sub_u32 s66, s66, 1
    s_cmp_lg_u32 s66, 0
    s_cbranch_scc1 L_gl4
L_V2:
    s_mov_b32 s39, 4
    s_sub_u32 s32, s16, 4
    s_mul_i32 s31, s32, 6144
    s_add_u32 s31, s31, 141312
    s_mov_b32 s33, 61440
    s_mov_b32 s64, -1
    s_mov_b32 s65, 22
    s_lshl_b32 s19, s32, 4
    v_add_u32 v14, s19, v4
    v_and_b32 v10, 7, v0
    v_bfe_u32 v11, v0, 4, 1
    v_lshl_or_b32 v10, v11, 3, v10
    v_lshrrev_b32 v11, 5, v0
    v_lshl_or_b32 v10, v11, 4, v10
    v_bfe_u32 v11, v0, 3, 1
    v_mul_u32_u24 v11, 3072, v11
    v_lshl_add_u32 v3, v10, 4, v11
    v_add_u32 v3, s31, v3
    v_and_b32 v10, 0x13, v0
    v_and_b32 v11, 4, v0
    v_and_b32 v12, 8, v0
    v_lshl_or_b32 v10, v11, 1, v10
    v_lshrrev_b32 v12, 1, v12
    v_or_b32 v10, v10, v12
    v_lshrrev_b32 v13, 5, v0
    v_bfe_u32 v11, v10, 2, 2
    v_xor_b32 v11, v11, v13
    v_mul_u32_u24 v10, 192, v10
    v_lshl_add_u32 v10, v11, 4, v10
    v_add_u32 v1, s33, v10
    v_xor_b32 v2, 32, v1
    s_lshl_b32 s19, s32, 6
    v_add_u32 v5, s19, v1
    v_add_u32 v6, s19, v2
    s_waitcnt vmcnt(0)
    s_mov_b64 exec, 1
    ds_inc_u32 v4, v4 offset:44
    s_mov_b64 exec, -1
    s_mov_b32 s19, 0x100000
L_V2l:
    ds_read_b32 v10, v4 offset:44
    s_sub_u32 s19, s19, 1
    s_cbranch_scc1 L_V2l_x
    s_waitcnt lgkmcnt(0)
    v_cmp_le_u32 vcc, 3, v10
    s_nop 0
    s_cbranch_vccz L_V2l
L_V2l_x:
    s_branch L_jV
L_w6:
    s_mov_b32 s37, 0
    s_mov_b32 s35, 0
    s_mov_b32 s33, 4
    s_mul_i32 s19, s18, 43691
    s_lshr_b32 s19, s19, 21
    s_mul_i32 s38, s19, 516096
    s_mul_i32 s19, s18, 1536
    s_add_u32 s38, s38, s19
    s_add_u32 s38, s38, s37
    s_mov_b32 s19, 95
    v_add_u32 v10, 0, v0
    v_cmp_lt_u32 s[76:77], s19, v10
    s_nop 1
    v_cndmask_b32 v11, 0, 1, s[76:77]
    v_mul_u32_u24 v12, 96, v11
    v_sub_u32 v10, v10, v12
    v_mul_u32_u24 v12, 43, v10
    v_lshrrev_b32 v12, 9, v12
    v_mul_u32_u24 v13, 12, v12
    v_sub_u32 v13, v10, v13
    v_lshrrev_b32 v14, 2, v12
    v_lshl_or_b32 v14, v11, 1, v14
    v_xor_b32 v14, v13, v14
    v_and_b32 v14, 3, v14
    v_and_b32 v13, 12, v13
    v_or_b32 v13, v13, v14
    v_mul_u32_u24 v12, 12, v12
    v_add_u32 v13, v13, v12
    v_lshlrev_b32 v13, 4, v13
    v_mul_u32_u24 v11, 73728, v11
    v_add_u32 v7, v13, v11
    v_add_u32 v10, 64, v0
    v_cmp_lt_u32 s[78:79], s19, v10
    s_nop 1
    v_cndmask_b32 v11, 0, 1, s[78:79]
    v_mul_u32_u24 v12, 96, v11
    v_sub_u32 v10, v10, v12
    v_mul_u32_u24 v12, 43, v10
    v_lshrrev_b32 v12, 9, v12
    v_mul_u32_u24 v13, 12, v12
    v_sub_u32 v13, v10, v13
    v_lshrrev_b32 v14, 2, v12
    v_lshl_or_b32 v14, v11, 1, v14
    v_xor_b32 v14, v13, v14
    v_and_b32 v14, 3, v14
    v_and_b32 v13, 12, v13
    v_or_b32 v13, v13, v14
    v_mul_u32_u24 v12, 12, v12
    v_add_u32 v13, v13, v12
    v_lshlrev_b32 v13, 4, v13
    v_mul_u32_u24 v11, 73728, v11
    v_add_u32 v8, v13, v11
    v_add_u32 v10, 128, v0
    v_cmp_lt_u32 s[80:81], s19, v10
    s_nop 1
    v_cndmask_b32 v11, 0, 1, s[80:81]
    v_mul_u32_u24 v12, 96, v11
    v_sub_u32 v10, v10, v12
    v_mul_u32_u24 v12, 43, v10
    v_lshrrev_b32 v12, 9, v12
    v_mul_u32_u24 v13, 12, v12
    v_sub_u32 v13, v10, v13
    v_lshrrev_b32 v14, 2, v12
    v_lshl_or_b32 v14, v11, 1, v14
    v_xor_b32 v14, v13, v14
    v_and_b32 v14, 3, v14
    v_and_b32 v13, 12, v13
    v_or_b32 v13, v13, v14
    v_mul_u32_u24 v12, 12, v12
    v_add_u32 v13, v13, v12
    v_lshlrev_b32 v13, 4, v13
    v_mul_u32_u24 v11, 73728, v11
    v_add_u32 v9, v13, v11
    v_lshrrev_b32 v13, 5, v0
    v_bfe_u32 v10, v0, 3, 2
    v_bfe_u32 v11, v0, 1, 1
    v_lshl_or_b32 v10, v10, 1, v11
    v_bfe_u32 v11, v0, 2, 1
    v_cmp_eq_u32 vcc, v11, v13
    v_mov_b32 v12, 99
    s_nop 0
    v_cndmask_b32 v10, v12, v10, vcc
    v_and_b32 v11, 1, v0
    v_lshlrev_b32 v11, 4, v11
    v_mov_b32 v12, 0x3f80
    v_lshlrev_b32 v11, v11, v12
    v_cmp_eq_u32 s[76:77], 0, v10
    s_nop 1
    v_cndmask_b32 v208, 0, v11, s[76:77]
    v_cmp_eq_u32 s[78:79], 1, v10
    s_nop 1
    v_cndmask_b32 v209, 0, v11, s[78:79]
    v_cmp_eq_u32 s[80:81], 2, v10
    s_nop 1
    v_cndmask_b32 v210, 0, v11, s[80:81]
    v_cmp_eq_u32 s[82:83], 3, v10
    s_nop 1
    v_cndmask_b32 v211, 0, v11, s[82:83]
    v_cmp_eq_u32 s[76:77], 4, v10
    s_nop 1
    v_cndmask_b32 v212, 0, v11, s[76:77]
    v_cmp_eq_u32 s[78:79], 5, v10
    s_nop 1
    v_cndmask_b32 v213, 0, v11, s[78:79]
    v_cmp_eq_u32 s[80:81], 6, v10
    s_nop 1
    v_cndmask_b32 v214, 0, v11, s[80:81]
    v_cmp_eq_u32 s[82:83], 7, v10
    s_nop 1
    v_cndmask_b32 v215, 0, v11, s[82:83]
    v_mov_b32 v15, 1
    s_barrier
    s_mov_b32 s19, 0x100000
L_w6i:
    ds_read_b32 v10, v4 offset:56
    s_sub_u32 s19, s19, 1
    s_cbranch_scc1 L_w6i_x
    s_waitcnt lgkmcnt(0)
    v_cmp_le_u32 vcc, 3, v10
    s_nop 0
    s_cbranch_vccz L_w6i
L_w6i_x:
L_w6l:
    s_add_u32 m0, s35, 0
    s_nop 0
    buffer_load_dwordx4 v7, s[4:7], s38 offen offset:0 nt lds
    v_xor_b32 v7, 16, v7
    s_add_u32 m0, s35, 1024
    s_nop 0
    buffer_load_dwordx4 v8, s[4:7], s38 offen offset:0 nt lds
    v_xor_b32 v8, 16, v8
    s_add_u32 m0, s35, 2048
    s_nop 0
    buffer_load_dwordx4 v9, s[4:7], s38 offen offset:0 nt lds
    v_xor_b32 v9, 16, v9
    s_add_u32 s38, s38, 28311552
    s_add_u32 m0, s35, 12288
    s_nop 0
    buffer_load_dwordx4 v7, s[4:7], s38 offen offset:0 nt lds
    v_xor_b32 v7, 32, v7
    s_add_u32 m0, s35, 13312
    s_nop 0
    buffer_load_dwordx4 v8, s[4:7], s38 offen offset:0 nt lds
    v_xor_b32 v8, 32, v8
    s_add_u32 m0, s35, 14336
    s_nop 0
    buffer_load_dwordx4 v9, s[4:7], s38 offen offset:0 nt lds
    v_xor_b32 v9, 32, v9
    s_add_u32 s38, s38, 56623104
    s_add_u32 m0, s35, 36864
    s_nop 0
    buffer_load_dwordx4 v7, s[4:7], s38 offen offset:0 nt lds
    v_xor_b32 v7, 16, v7
    s_add_u32 m0, s35, 37888
    s_nop 0
    buffer_load_dwordx4 v8, s[4:7], s38 offen offset:0 nt lds
    v_xor_b32 v8, 16, v8
    s_add_u32 m0, s35, 38912
    s_nop 0
    buffer_load_dwordx4 v9, s[4:7], s38 offen offset:0 nt lds
    v_xor_b32 v9, 16, v9
    s_sub_u32 s38, s38, 28311552
    s_add_u32 m0, s35, 24576
    s_nop 0
    buffer_load_dwordx4 v7, s[4:7], s38 offen offset:0 nt lds
    v_xor_b32 v7, 32, v7
    s_add_u32 m0, s35, 25600
    s_nop 0
    buffer_load_dwordx4 v8, s[4:7], s38 offen offset:0 nt lds
    v_xor_b32 v8, 32, v8
    s_add_u32 m0, s35, 26624
    s_nop 0
    buffer_load_dwordx4 v9, s[4:7], s38 offen offset:0 nt lds
    v_xor_b32 v9, 32, v9
    s_add_u32 s35, s35, 3072
    s_sub_u32 s38, s38, 56475648
    s_sub_u32 s33, s33, 1
    s_cmp_lg_u32 s33, 0
    s_cbranch_scc1 L_w6l
    s_waitcnt vmcnt(0)
    s_mov_b64 exec, 1
    ds_inc_u32 v4, v4 offset:8
    s_mov_b64 exec, -1
    s_setprio 0
    s_branch L_V2
L_Mc_slow:
    s_mov_b32 s19, 0x100000
L_Mc_sl:
    ds_read_b32 v16, v4 offset:24
    s_waitcnt lgkmcnt(0)
    s_sub_u32 s19, s19, 1
    s_cbranch_scc1 L_Mc_back
    v_and_b32 v16, s64, v16
    v_cmp_le_u32 vcc, s65, v16
    s_nop 0
    s_cbranch_vccz L_Mc_sl
    s_branch L_Mc_back
L_Vc_slow:
    s_mov_b32 s19, 0x100000
L_Vc_sl:
    ds_read_b32 v16, v4 offset:24
    s_waitcnt lgkmcnt(0)
    s_sub_u32 s19, s19, 1
    s_cbranch_scc1 L_Vc_back
    v_and_b32 v16, s64, v16
    v_cmp_le_u32 vcc, s65, v16
    s_nop 0
    s_cbranch_vccz L_Vc_sl
    s_branch L_Vc_back
L_T:
    s_mov_b32 s97, 0
    s_mul_i32 s37, s16, 147456
    s_mul_i32 s35, s16, 3072
    s_add_u32 s35, s35, s34
    s_mov_b32 s19, 95
    v_add_u32 v10, 0, v0
    v_cmp_lt_u32 s[76:77], s19, v10
    s_nop 1
    v_cndmask_b32 v11, 0, 1, s[76:77]
    v_mul_u32_u24 v12, 96, v11
    v_sub_u32 v10, v10, v12
    v_mul_u32_u24 v12, 43, v10
    v_lshrrev_b32 v12, 9, v12
    v_mul_u32_u24 v13, 12, v12
    v_sub_u32 v13, v10, v13
    v_lshrrev_b32 v14, 2, v12
    v_lshl_or_b32 v14, v11, 1, v14
    v_xor_b32 v14, v13, v14
    v_and_b32 v14, 3, v14
    v_and_b32 v13, 12, v13
    v_or_b32 v13, v13, v14
    v_mul_u32_u24 v12, 12, v12
    v_add_u32 v13, v13, v12
    v_lshlrev_b32 v13, 4, v13
    v_mul_u32_u24 v11, 73728, v11
    v_add_u32 v7, v13, v11
    v_add_u32 v10, 64, v0
    v_cmp_lt_u32 s[78:79], s19, v10
    s_nop 1
    v_cndmask_b32 v11, 0, 1, s[78:79]
    v_mul_u32_u24 v12, 96, v11
    v_sub_u32 v10, v10, v12
    v_mul_u32_u24 v12, 43, v10
    v_lshrrev_b32 v12, 9, v12
    v_mul_u32_u24 v13, 12, v12
    v_sub_u32 v13, v10, v13
    v_lshrrev_b32 v14, 2, v12
    v_lshl_or_b32 v14, v11, 1, v14
    v_xor_b32 v14, v13, v14
    v_and_b32 v14, 3, v14
    v_and_b32 v13, 12, v13
    v_or_b32 v13, v13, v14
    v_mul_u32_u24 v12, 12, v12
    v_add_u32 v13, v13, v12
    v_lshlrev_b32 v13, 4, v13
    v_mul_u32_u24 v11, 73728, v11
    v_add_u32 v8, v13, v11
    v_add_u32 v10, 128, v0
    v_cmp_lt_u32 s[80:81], s19, v10
    s_nop 1
    v_cndmask_b32 v11, 0, 1, s[80:81]
    v_mul_u32_u24 v12, 96, v11
    v_sub_u32 v10, v10, v12
    v_mul_u32_u24 v12, 43, v10
    v_lshrrev_b32 v12, 9, v12
    v_mul_u32_u24 v13, 12, v12
    v_sub_u32 v13, v10, v13
    v_lshrrev_b32 v14, 2, v12
    v_lshl_or_b32 v14, v11, 1, v14
    v_xor_b32 v14, v13, v14
    v_and_b32 v14, 3, v14
    v_and_b32 v13, 12, v13
    v_or_b32 v13, v13, v14
    v_mul_u32_u24 v12, 12, v12
    v_add_u32 v13, v13, v12
    v_lshlrev_b32 v13, 4, v13
    v_mul_u32_u24 v11, 73728, v11
    v_add_u32 v9, v13, v11
    v_mov_b32 v26, v4
    v_lshlrev_b32 v25, 4, v0
    v_add_u32 v5, 98304, v25
    s_mul_i32 s39, s16, 3072
    v_and_b32 v20, 3, v0
    v_bfe_u32 v21, v0, 2, 2
    v_lshrrev_b32 v22, 4, v0
    v_xor_b32 v23, v20, v22
    v_lshlrev_b32 v23, 4, v23
    v_mul_u32_u24 v24, 12288, v20
    v_add_u32 v23, v23, v24
    v_mul_u32_u24 v24, 192, v21
    v_add3_u32 v1, v23, v24, s39
    v_xor_b32 v2, 16, v1
    v_xor_b32 v3, 32, v1
    v_xor_b32 v4, 48, v1
    v_sub_u32 v23, v21, v22
    v_and_b32 v23, 3, v23
    v_lshl_add_u32 v23, v23, 2, v22
    v_mul_u32_u24 v24, 72, v20
    v_add_u32 v23, v23, v24
    s_lshl_b32 s19, s16, 6
    s_add_u32 s19, s19, 160896
    v_lshl_add_u32 v6, v23, 2, s19
    v_cmp_eq_u32 vcc, v21, v22
    s_nop 1
    v_cndmask_b32 v10, 0, -1, vcc
    v_and_b32 v23, 1, v0
    v_lshlrev_b32 v23, 4, v23
    v_mov_b32 v24, 0x3f80
    v_lshlrev_b32 v23, v23, v24
    v_cmp_gt_u32 vcc, 2, v20
    s_nop 1
    v_cndmask_b32 v16, 0, v23, vcc
    v_cndmask_b32 v17, v23, 0, vcc
    v_and_b32 v226, v16, v10
    v_and_b32 v227, v17, v10
    v_and_b32 v232, v16, v10
    v_and_b32 v233, v17, v10
    v_and_b32 v238, v16, v10
    v_and_b32 v239, v17, v10
    v_and_b32 v244, v16, v10
    v_and_b32 v245, v17, v10
    v_mov_b32 v12, 0x3f803f80
    v_mov_b32 v13, 0x3f803f80
    v_mov_b32 v14, 0x3f803f80
    v_mov_b32 v15, 0x3f803f80
    s_mov_b32 s42, 0x3727c5ac
    s_mov_b32 s20, 0xf0ffff0f
    s_mov_b32 s21, 0xfff00fff
    s_mov_b32 s22, 0xffff0ff
    s_mov_b32 s23, 0xff0ffff0
    s_mov_b32 s24, 0xfff00fff
    s_mov_b32 s25, 0xf0ffff0f
    s_mov_b32 s28, 0x22222222
    s_mov_b32 s29, 0x22222222
    s_mov_b32 s30, 0x44444444
    s_mov_b32 s31, 0x44444444
    s_mov_b32 s32, 0x88888888
    s_mov_b32 s33, 0x88888888
    s_mov_b32 s19, 0x100000
L_Tw:
    ds_read_b32 v27, v26 offset:8
    s_sub_u32 s19, s19, 1
    s_cbranch_scc1 L_Tw_x
    s_waitcnt lgkmcnt(0)
    v_cmp_le_u32 vcc, 7, v27
    s_nop 0
    s_cbranch_vccz L_Tw
L_Tw_x:
    ds_read_b128 v[104:107], v25 offset:49152
    ds_read_b128 v[108:111], v25 offset:50176
    ds_read_b128 v[112:115], v25 offset:51200
    ds_read_b128 v[116:119], v25 offset:52224
    ds_read_b128 v[120:123], v25 offset:53248
    ds_read_b128 v[124:127], v25 offset:54272
    ds_read_b128 v[128:131], v25 offset:55296
    ds_read_b128 v[132:135], v25 offset:56320
    ds_read_b128 v[136:139], v25 offset:57344
    ds_read_b128 v[140:143], v25 offset:58368
    ds_read_b128 v[144:147], v25 offset:59392
    ds_read_b128 v[148:151], v25 offset:60416
    s_waitcnt lgkmcnt(0)
    s_lshl_b64 exec, 1, s16
    ds_inc_u32 v5, v5 offset:63744
    s_mov_b64 exec, -1
    s_mov_b32 s36, 2
    s_mov_b32 s40, -1152
    s_setprio 3
L_Tloop:
    s_waitcnt vmcnt(0)
    ds_read_b128 v[26:29], v1 offset:0
    ds_read_b128 v[32:35], v1 offset:64
    ds_read_b128 v[38:41], v1 offset:128
    ds_read_b128 v[46:49], v2 offset:768
    ds_read_b128 v[52:55], v2 offset:832
    ds_read_b128 v[58:61], v2 offset:896
    ds_read_b128 v[66:69], v3 offset:1536
    ds_read_b128 v[72:75], v3 offset:1600
    ds_read_b128 v[78:81], v3 offset:1664
    ds_read_b128 v[86:89], v4 offset:2304
    ds_read_b128 v[92:95], v4 offset:2368
    ds_read_b128 v[98:101], v4 offset:2432
    v_cndmask_b32 v152, v152, v153, s[28:29]
    v_cndmask_b32 v160, v160, v161, s[28:29]
    v_cndmask_b32 v168, v168, v169, s[28:29]
    v_cndmask_b32 v152, v152, v154, s[30:31]
    v_cndmask_b32 v160, v160, v162, s[30:31]
    v_cndmask_b32 v168, v168, v170, s[30:31]
    v_cndmask_b32 v152, v152, v155, s[32:33]
    v_cndmask_b32 v160, v160, v163, s[32:33]
    s_mov_b64 vcc, s[20:21]
    v_cndmask_b32 v168, v168, v171, s[32:33]
    v_cndmask_b32_dpp v156, v164, v156, vcc row_ror:4 row_mask:0xf bank_mask:0xf
    v_cndmask_b32_dpp v152, v160, v152, vcc row_ror:4 row_mask:0xf bank_mask:0xf
    s_mov_b64 vcc, s[22:23]
    v_cndmask_b32 v176, v176, v177, s[28:29]
    v_cndmask_b32_dpp v156, v172, v156, vcc row_ror:8 row_mask:0xf bank_mask:0xf
    v_cndmask_b32_dpp v152, v168, v152, vcc row_ror:8 row_mask:0xf bank_mask:0xf
    s_mov_b64 vcc, s[24:25]
    v_cndmask_b32 v176, v176, v178, s[30:31]
    v_cndmask_b32_dpp v156, v180, v156, vcc row_ror:12 row_mask:0xf bank_mask:0xf
    v_cndmask_b32 v176, v176, v179, s[32:33]
    v_mul_f32 v156, 0x3c2aaaab, v156
    s_add_u32 s18, s18, 256
    v_cndmask_b32_dpp v152, v176, v152, vcc row_ror:12 row_mask:0xf bank_mask:0xf
    v_fma_f32 v156, -v156, v156, s42
    s_mul_i32 s19, s18, 43691
    v_fmamk_f32 v152, v152, 0x3c2aaaab, v156
    s_lshr_b32 s19, s19, 21
    v_max_f32 v152, s42, v152
    s_setprio 0
    s_waitcnt lgkmcnt(6)
    v_mfma_f32_16x16x32_bf16 v[200:203], v[104:107], v[26:29], 0
    s_setprio 3
    v_rsq_f32 v153, v152
    s_setprio 0
    v_mfma_f32_16x16x32_bf16 v[200:203], v[108:111], v[32:35], v[200:203]
    ds_write_b32 v6, v153 offset:0
    v_mfma_f32_16x16x32_bf16 v[200:203], v[112:115], v[38:41], v[200:203]
    s_mul_i32 s38, s19, 516096
    s_mul_i32 s19, s18, 1536
    v_mfma_f32_16x16x32_bf16 v[204:207], v[116:119], v[26:29], 0
    s_add_u32 s38, s38, s19
    s_add_u32 s38, s38, s37
    v_mfma_f32_16x16x32_bf16 v[204:207], v[120:123], v[32:35], v[204:207]
    s_setprio 3
    v_cvt_pk_bf16_f32 v200, v200, v201
    v_cvt_pk_bf16_f32 v201, v202, v203
    s_setprio 0
    v_mfma_f32_16x16x32_bf16 v[204:207], v[124:127], v[38:41], v[204:207]
    s_cmp_ge_u32 s17, 8
    s_cselect_b32 s38, 0x7000000, s38
    s_lshl_b64 exec, 1, s16
    ds_inc_u32 v5, v5 offset:63748
    s_mov_b64 exec, -1
    v_mfma_f32_16x16x32_bf16 v[208:211], v[104:107], v[46:49], 0
    s_setprio 3
    v_add_u32 v6, s40, v6
    s_setprio 0
    v_mfma_f32_16x16x32_bf16 v[208:211], v[108:111], v[52:55], v[208:211]
    s_setprio 3
    v_cvt_pk_bf16_f32 v202, v204, v205
    v_cvt_pk_bf16_f32 v203, v206, v207
    s_setprio 0
    v_mfma_f32_16x16x32_bf16 v[208:211], v[112:115], v[58:61], v[208:211]
    ds_read_b128 v[204:207], v5 offset:1024
    v_mfma_f32_16x16x32_bf16 v[212:215], v[116:119], v[46:49], 0
    v_mfma_f32_16x16x32_bf16 v[212:215], v[120:123], v[52:55], v[212:215]
    s_setprio 3
    v_cvt_pk_bf16_f32 v208, v208, v209
    v_cvt_pk_bf16_f32 v209, v210, v211
    s_setprio 0
    v_mfma_f32_16x16x32_bf16 v[212:215], v[124:127], v[58:61], v[212:215]
    v_mfma_f32_16x16x32_bf16 v[184:187], v[26:29], v[200:203], 0
    ds_read_b128 v[200:203], v5 offset:0
    s_waitcnt lgkmcnt(3)
    v_mfma_f32_16x16x32_bf16 v[216:219], v[104:107], v[66:69], 0
    s_setprio 3
    v_cvt_pk_bf16_f32 v210, v212, v213
    v_cvt_pk_bf16_f32 v211, v214, v215
    s_setprio 0
    v_mfma_f32_16x16x32_bf16 v[216:219], v[108:111], v[72:75], v[216:219]
    ds_read_b128 v[212:215], v5 offset:3072
    v_mfma_f32_16x16x32_bf16 v[216:219], v[112:115], v[78:81], v[216:219]
    v_mfma_f32_16x16x32_bf16 v[220:223], v[116:119], v[66:69], 0
    v_mfma_f32_16x16x32_bf16 v[220:223], v[120:123], v[72:75], v[220:223]
    s_setprio 3
    v_cvt_pk_bf16_f32 v216, v216, v217
    v_cvt_pk_bf16_f32 v217, v218, v219
    s_setprio 0
    v_mfma_f32_16x16x32_bf16 v[220:223], v[124:127], v[78:81], v[220:223]
    v_mfma_f32_16x16x32_bf16 v[188:191], v[46:49], v[208:211], 0
    ds_read_b128 v[208:211], v5 offset:2048
    v_mfma_f32_16x16x32_bf16 v[248:251], v[104:107], v[86:89], 0
    s_setprio 3
    v_cvt_pk_bf16_f32 v218, v220, v221
    v_cvt_pk_bf16_f32 v219, v222, v223
    s_setprio 0
    v_mfma_f32_16x16x32_bf16 v[248:251], v[108:111], v[92:95], v[248:251]
    ds_read_b128 v[220:223], v5 offset:5120
    v_mfma_f32_16x16x32_bf16 v[248:251], v[112:115], v[98:101], v[248:251]
    v_mfma_f32_16x16x32_bf16 v[252:255], v[116:119], v[86:89], 0
    v_mfma_f32_16x16x32_bf16 v[252:255], v[120:123], v[92:95], v[252:255]
    s_setprio 3
    v_cvt_pk_bf16_f32 v248, v248, v249
    v_cvt_pk_bf16_f32 v249, v250, v251
    s_setprio 0
    v_mfma_f32_16x16x32_bf16 v[252:255], v[124:127], v[98:101], v[252:255]
    ds_read_b32 v11, v5 offset:63744
    v_mfma_f32_16x16x32_bf16 v[192:195], v[66:69], v[216:219], 0
    ds_read_b128 v[216:219], v5 offset:4096
    v_mfma_f32_16x16x32_bf16 v[152:155], v[26:29], v[26:29], 0
    s_setprio 3
    v_cvt_pk_bf16_f32 v250, v252, v253
    v_cvt_pk_bf16_f32 v251, v254, v255
    s_setprio 0
    v_mfma_f32_16x16x32_bf16 v[152:155], v[32:35], v[32:35], v[152:155]
    v_mfma_f32_16x16x32_bf16 v[152:155], v[38:41], v[38:41], v[152:155]
    v_mfma_f32_16x16x32_bf16 v[156:159], v[12:15], v[26:29], 0
    v_mfma_f32_16x16x32_bf16 v[156:159], v[12:15], v[32:35], v[156:159]
    s_setprio 3
    v_cndmask_b32 v152, v152, v153, s[28:29]
    s_setprio 0
    v_mfma_f32_16x16x32_bf16 v[156:159], v[12:15], v[38:41], v[156:159]
    s_setprio 3
    v_cndmask_b32 v152, v152, v154, s[30:31]
    s_setprio 0
    v_mfma_f32_16x16x32_bf16 v[196:199], v[86:89], v[248:251], 0
    s_setprio 3
    v_cndmask_b32 v152, v152, v155, s[32:33]
    s_setprio 0
    v_mfma_f32_16x16x32_bf16 v[160:163], v[46:49], v[46:49], 0
    v_mfma_f32_16x16x32_bf16 v[160:163], v[52:55], v[52:55], v[160:163]
    v_mfma_f32_16x16x32_bf16 v[160:163], v[58:61], v[58:61], v[160:163]
    v_mfma_f32_16x16x32_bf16 v[164:167], v[12:15], v[46:49], 0
    s_waitcnt lgkmcnt(0)
    v_cmp_le_u32 vcc, s36, v11
    s_nop 0
    s_and_b32 s41, vcc_lo, 15
    s_cmp_lg_u32 s41, 15
    s_cbranch_scc1 L_Tc_slow
L_Tc_back:
    v_mfma_f32_16x16x32_bf16 v[164:167], v[12:15], v[52:55], v[164:167]
    s_setprio 3
    v_cndmask_b32 v160, v160, v161, s[28:29]
    s_mov_b64 vcc, s[20:21]
    s_setprio 0
    v_mfma_f32_16x16x32_bf16 v[164:167], v[12:15], v[58:61], v[164:167]
    s_setprio 3
    v_cndmask_b32 v160, v160, v162, s[30:31]
    s_add_u32 m0, s35, 0
    s_setprio 0
    v_mfma_f32_16x16x32_bf16 v[168:171], v[66:69], v[66:69], 0
    s_setprio 3
    v_cndmask_b32 v160, v160, v163, s[32:33]
    buffer_load_dwordx4 v7, s[4:7], s38 offen offset:0 nt lds
    s_setprio 0
    v_mfma_f32_16x16x32_bf16 v[168:171], v[72:75], v[72:75], v[168:171]
    s_setprio 3
    v_cndmask_b32_dpp v156, v164, v156, vcc row_ror:4 row_mask:0xf bank_mask:0xf
    v_cndmask_b32_dpp v152, v160, v152, vcc row_ror:4 row_mask:0xf bank_mask:0xf
    s_setprio 0
    v_mfma_f32_16x16x32_bf16 v[168:171], v[78:81], v[78:81], v[168:171]
    s_mov_b64 vcc, s[22:23]
    s_add_u32 m0, s35, 1024
    v_mfma_f32_16x16x32_bf16 v[172:175], v[12:15], v[66:69], 0
    buffer_load_dwordx4 v8, s[4:7], s38 offen offset:0 nt lds
    v_mfma_f32_16x16x32_bf16 v[172:175], v[12:15], v[72:75], v[172:175]
    s_setprio 3
    v_cndmask_b32 v168, v168, v169, s[28:29]
    v_xor_b32 v7, 16, v7
    s_setprio 0
    v_mfma_f32_16x16x32_bf16 v[172:175], v[12:15], v[78:81], v[172:175]
    s_setprio 3
    v_cndmask_b32 v168, v168, v170, s[30:31]
    v_xor_b32 v8, 16, v8
    s_setprio 0
    v_mfma_f32_16x16x32_bf16 v[176:179], v[86:89], v[86:89], 0
    s_setprio 3
    v_cndmask_b32 v168, v168, v171, s[32:33]
    s_setprio 0
    v_mfma_f32_16x16x32_bf16 v[176:179], v[92:95], v[92:95], v[176:179]
    s_setprio 3
    v_cndmask_b32_dpp v156, v172, v156, vcc row_ror:8 row_mask:0xf bank_mask:0xf
    v_cndmask_b32_dpp v152, v168, v152, vcc row_ror:8 row_mask:0xf bank_mask:0xf
    s_setprio 0
    v_mfma_f32_16x16x32_bf16 v[176:179], v[98:101], v[98:101], v[176:179]
    s_mov_b64 vcc, s[24:25]
    s_add_u32 m0, s35, 2048
    v_mfma_f32_16x16x32_bf16 v[180:183], v[12:15], v[86:89], 0
    buffer_load_dwordx4 v9, s[4:7], s38 offen offset:0 nt lds
    v_mfma_f32_16x16x32_bf16 v[180:183], v[12:15], v[92:95], v[180:183]
    s_setprio 3
    v_cndmask_b32 v176, v176, v177, s[28:29]
    s_add_u32 s38, s38, 28311552
    s_setprio 0
    v_mfma_f32_16x16x32_bf16 v[180:183], v[12:15], v[98:101], v[180:183]
    s_setprio 3
    v_cndmask_b32 v176, v176, v178, s[30:31]
    v_xor_b32 v9, 16, v9
    s_setprio 0
    v_mfma_f32_16x16x32_bf16 v[16:19], v[128:131], v[26:29], 0
    s_setprio 3
    v_cndmask_b32 v176, v176, v179, s[32:33]
    s_add_u32 m0, s35, 12288
    s_setprio 0
    v_mfma_f32_16x16x32_bf16 v[16:19], v[132:135], v[32:35], v[16:19]
    s_setprio 3
    v_cndmask_b32_dpp v156, v180, v156, vcc row_ror:12 row_mask:0xf bank_mask:0xf
    v_cndmask_b32_dpp v152, v176, v152, vcc row_ror:12 row_mask:0xf bank_mask:0xf
    s_setprio 0
    v_mfma_f32_16x16x32_bf16 v[16:19], v[136:139], v[38:41], v[16:19]
    s_setprio 3
    v_mul_f32 v156, 0x3c2aaaab, v156
    s_mov_b64 vcc, s[20:21]
    s_setprio 0
    v_mfma_f32_16x16x32_bf16 v[20:23], v[140:143], v[26:29], 0
    s_setprio 3
    v_fma_f32 v156, -v156, v156, s42
    buffer_load_dwordx4 v7, s[4:7], s38 offen offset:0 nt lds
    s_setprio 0
    v_mfma_f32_16x16x32_bf16 v[20:23], v[144:147], v[32:35], v[20:23]
    s_setprio 3
    v_cvt_pk_bf16_f32 v16, v16, v17
    v_cvt_pk_bf16_f32 v17, v18, v19
    s_setprio 0
    v_mfma_f32_16x16x32_bf16 v[20:23], v[148:151], v[38:41], v[20:23]
    s_setprio 3
    v_fmamk_f32 v152, v152, 0x3c2aaaab, v156
    s_add_u32 m0, s35, 13312
    s_setprio 0
    v_mfma_f32_16x16x32_bf16 v[248:251], v[128:131], v[46:49], 0
    s_setprio 3
    v_max_f32 v152, s42, v152
    buffer_load_dwordx4 v8, s[4:7], s38 offen offset:0 nt lds
    s_setprio 0
    v_mfma_f32_16x16x32_bf16 v[248:251], v[132:135], v[52:55], v[248:251]
    s_setprio 3
    v_cvt_pk_bf16_f32 v18, v20, v21
    v_cvt_pk_bf16_f32 v19, v22, v23
    s_setprio 0
    v_mfma_f32_16x16x32_bf16 v[248:251], v[136:139], v[58:61], v[248:251]
    s_setprio 3
    v_rsq_f32 v0, v152
    s_setprio 0
    v_mfma_f32_16x16x32_bf16 v[252:255], v[140:143], v[46:49], 0
    s_setprio 3
    v_xor_b32 v7, 32, v7
    v_xor_b32 v8, 32, v8
    s_setprio 0
    v_mfma_f32_16x16x32_bf16 v[252:255], v[144:147], v[52:55], v[252:255]
    s_setprio 3
    v_cvt_pk_bf16_f32 v248, v248, v249
    v_cvt_pk_bf16_f32 v249, v250, v251
    s_setprio 0
    v_mfma_f32_16x16x32_bf16 v[252:255], v[148:151], v[58:61], v[252:255]
    s_add_u32 m0, s35, 14336
    v_mfma_f32_16x16x32_bf16 v[184:187], v[32:35], v[16:19], v[184:187]
    buffer_load_dwordx4 v9, s[4:7], s38 offen offset:0 nt lds
    v_mfma_f32_16x16x32_bf16 v[16:19], v[128:131], v[66:69], 0
    s_setprio 3
    v_cvt_pk_bf16_f32 v250, v252, v253
    v_cvt_pk_bf16_f32 v251, v254, v255
    s_setprio 0
    v_mfma_f32_16x16x32_bf16 v[16:19], v[132:135], v[72:75], v[16:19]
    s_setprio 3
    s_add_u32 s38, s38, 56623104
    v_xor_b32 v9, 32, v9
    s_setprio 0
    v_mfma_f32_16x16x32_bf16 v[16:19], v[136:139], v[78:81], v[16:19]
    s_add_u32 m0, s35, 36864
    v_mfma_f32_16x16x32_bf16 v[20:23], v[140:143], v[66:69], 0
    buffer_load_dwordx4 v7, s[4:7], s38 offen offset:0 nt lds
    v_mfma_f32_16x16x32_bf16 v[20:23], v[144:147], v[72:75], v[20:23]
    s_setprio 3
    v_cvt_pk_bf16_f32 v16, v16, v17
    v_cvt_pk_bf16_f32 v17, v18, v19
    s_setprio 0
    v_mfma_f32_16x16x32_bf16 v[20:23], v[148:151], v[78:81], v[20:23]
    s_setprio 3
    v_xor_b32 v7, 16, v7
    s_setprio 0
    v_mfma_f32_16x16x32_bf16 v[188:191], v[52:55], v[248:251], v[188:191]
    v_mfma_f32_16x16x32_bf16 v[248:251], v[128:131], v[86:89], 0
    s_setprio 3
    v_cvt_pk_bf16_f32 v18, v20, v21
    v_cvt_pk_bf16_f32 v19, v22, v23
    s_setprio 0
    v_mfma_f32_16x16x32_bf16 v[248:251], v[132:135], v[92:95], v[248:251]
    s_add_u32 m0, s35, 37888
    v_mfma_f32_16x16x32_bf16 v[248:251], v[136:139], v[98:101], v[248:251]
    buffer_load_dwordx4 v8, s[4:7], s38 offen offset:0 nt lds
    v_mfma_f32_16x16x32_bf16 v[252:255], v[140:143], v[86:89], 0
    s_setprio 3
    v_xor_b32 v8, 16, v8
    s_setprio 0
    v_mfma_f32_16x16x32_bf16 v[252:255], v[144:147], v[92:95], v[252:255]
    s_setprio 3
    v_cvt_pk_bf16_f32 v248, v248, v249
    v_cvt_pk_bf16_f32 v249, v250, v251
    s_setprio 0
    v_mfma_f32_16x16x32_bf16 v[252:255], v[148:151], v[98:101], v[252:255]
    s_add_u32 m0, s35, 38912
    v_mfma_f32_16x16x32_bf16 v[192:195], v[72:75], v[16:19], v[192:195]
    buffer_load_dwordx4 v9, s[4:7], s38 offen offset:0 nt lds
    v_mfma_f32_16x16x32_bf16 v[152:155], v[200:203], v[26:29], 0
    s_setprio 3
    v_cvt_pk_bf16_f32 v250, v252, v253
    v_cvt_pk_bf16_f32 v251, v254, v255
    s_setprio 0
    v_mfma_f32_16x16x32_bf16 v[152:155], v[204:207], v[32:35], v[152:155]
    s_setprio 3
    s_sub_u32 s38, s38, 28311552
    v_xor_b32 v9, 16, v9
    s_setprio 0
    v_mfma_f32_16x16x32_bf16 v[152:155], v[208:211], v[38:41], v[152:155]
    v_mfma_f32_16x16x32_bf16 v[196:199], v[92:95], v[248:251], v[196:199]
    s_add_u32 m0, s35, 24576
    v_mfma_f32_16x16x32_bf16 v[160:163], v[200:203], v[46:49], 0
    s_setprio 3
    v_cvt_pk_bf16_f32 v152, v152, v153
    v_cvt_pk_bf16_f32 v153, v154, v155
    s_setprio 0
    v_mfma_f32_16x16x32_bf16 v[160:163], v[204:207], v[52:55], v[160:163]
    buffer_load_dwordx4 v7, s[4:7], s38 offen offset:0 nt lds
    v_mfma_f32_16x16x32_bf16 v[160:163], v[208:211], v[58:61], v[160:163]
    s_setprio 3
    v_xor_b32 v7, 32, v7
    s_setprio 0
    v_mfma_f32_16x16x32_bf16 v[168:171], v[200:203], v[66:69], 0
    v_mfma_f32_16x16x32_bf16 v[168:171], v[204:207], v[72:75], v[168:171]
    s_setprio 3
    v_cvt_pk_bf16_f32 v160, v160, v161
    v_cvt_pk_bf16_f32 v161, v162, v163
    s_setprio 0
    v_mfma_f32_16x16x32_bf16 v[168:171], v[208:211], v[78:81], v[168:171]
    s_add_u32 m0, s35, 25600
    v_mfma_f32_16x16x32_bf16 v[176:179], v[200:203], v[86:89], 0
    ds_read_b128 v[200:203], v5 offset:6144
    buffer_load_dwordx4 v8, s[4:7], s38 offen offset:0 nt lds
    v_mfma_f32_16x16x32_bf16 v[176:179], v[204:207], v[92:95], v[176:179]
    s_setprio 3
    ds_read_b128 v[204:207], v5 offset:7168
    v_cvt_pk_bf16_f32 v168, v168, v169
    s_setprio 0
    v_mfma_f32_16x16x32_bf16 v[176:179], v[208:211], v[98:101], v[176:179]
    s_setprio 3
    ds_read_b128 v[208:211], v5 offset:8192
    v_cvt_pk_bf16_f32 v169, v170, v171
    s_setprio 0
    v_mfma_f32_16x16x32_bf16 v[156:159], v[212:215], v[26:29], 0
    s_setprio 3
    s_add_u32 m0, s35, 26624
    v_xor_b32 v8, 32, v8
    s_setprio 0
    v_mfma_f32_16x16x32_bf16 v[156:159], v[216:219], v[32:35], v[156:159]
    s_setprio 3
    v_cvt_pk_bf16_f32 v176, v176, v177
    v_cvt_pk_bf16_f32 v177, v178, v179
    s_setprio 0
    v_mfma_f32_16x16x32_bf16 v[156:159], v[220:223], v[38:41], v[156:159]
    buffer_load_dwordx4 v9, s[4:7], s38 offen offset:0 nt lds
    v_mfma_f32_16x16x32_bf16 v[164:167], v[212:215], v[46:49], 0
    s_setprio 3
    v_xor_b32 v9, 32, v9
    s_setprio 0
    v_mfma_f32_16x16x32_bf16 v[164:167], v[216:219], v[52:55], v[164:167]
    s_setprio 3
    v_cvt_pk_bf16_f32 v154, v156, v157
    v_cvt_pk_bf16_f32 v155, v158, v159
    s_setprio 0
    v_mfma_f32_16x16x32_bf16 v[164:167], v[220:223], v[58:61], v[164:167]
    v_mfma_f32_16x16x32_bf16 v[184:187], v[38:41], v[152:155], v[184:187]
    v_mfma_f32_16x16x32_bf16 v[172:175], v[212:215], v[66:69], 0
    s_setprio 3
    v_cvt_pk_bf16_f32 v162, v164, v165
    v_cvt_pk_bf16_f32 v163, v166, v167
    s_setprio 0
    v_mfma_f32_16x16x32_bf16 v[172:175], v[216:219], v[72:75], v[172:175]
    v_mfma_f32_16x16x32_bf16 v[172:175], v[220:223], v[78:81], v[172:175]
    v_mfma_f32_16x16x32_bf16 v[188:191], v[58:61], v[160:163], v[188:191]
    v_mfma_f32_16x16x32_bf16 v[180:183], v[212:215], v[86:89], 0
    s_setprio 3
    v_cvt_pk_bf16_f32 v170, v172, v173
    v_cvt_pk_bf16_f32 v171, v174, v175
    s_setprio 0
    v_mfma_f32_16x16x32_bf16 v[180:183], v[216:219], v[92:95], v[180:183]
    ds_read_b128 v[212:215], v5 offset:9216
    ds_read_b128 v[216:219], v5 offset:10240
    v_mfma_f32_16x16x32_bf16 v[180:183], v[220:223], v[98:101], v[180:183]
    s_setprio 3
    ds_read_b128 v[220:223], v5 offset:11264
    v_cndmask_b32_dpp v184, v188, v184, vcc row_ror:4 row_mask:0xf bank_mask:0xf
    s_setprio 0
    v_mfma_f32_16x16x32_bf16 v[192:195], v[78:81], v[168:171], v[192:195]
    s_setprio 3
    v_cndmask_b32_dpp v185, v189, v185, vcc row_ror:4 row_mask:0xf bank_mask:0xf
    v_cndmask_b32_dpp v186, v190, v186, vcc row_ror:4 row_mask:0xf bank_mask:0xf
    s_setprio 0
    s_waitcnt lgkmcnt(3)
    v_mfma_f32_16x16x32_bf16 v[248:251], v[26:29], v[200:203], 0
    s_setprio 3
    v_cvt_pk_bf16_f32 v178, v180, v181
    v_cvt_pk_bf16_f32 v179, v182, v183
    s_setprio 0
    v_mfma_f32_16x16x32_bf16 v[248:251], v[32:35], v[204:207], v[248:251]
    s_setprio 3
    v_cndmask_b32_dpp v187, v191, v187, vcc row_ror:4 row_mask:0xf bank_mask:0xf
    s_mov_b64 vcc, s[22:23]
    s_setprio 0
    v_mfma_f32_16x16x32_bf16 v[248:251], v[38:41], v[208:211], v[248:251]
    s_setprio 3
    v_cndmask_b32_dpp v184, v192, v184, vcc row_ror:8 row_mask:0xf bank_mask:0xf
    v_cndmask_b32_dpp v185, v193, v185, vcc row_ror:8 row_mask:0xf bank_mask:0xf
    s_setprio 0
    v_mfma_f32_16x16x32_bf16 v[196:199], v[98:101], v[176:179], v[196:199]
    s_setprio 3
    v_cndmask_b32_dpp v186, v194, v186, vcc row_ror:8 row_mask:0xf bank_mask:0xf
    v_cndmask_b32_dpp v187, v195, v187, vcc row_ror:8 row_mask:0xf bank_mask:0xf
    s_setprio 0
    v_mfma_f32_16x16x32_bf16 v[252:255], v[46:49], v[200:203], 0
    s_setprio 3
    v_cvt_pk_bf16_f32 v224, v248, v249
    v_cvt_pk_bf16_f32 v225, v250, v251
    s_setprio 0
    v_mfma_f32_16x16x32_bf16 v[252:255], v[52:55], v[204:207], v[252:255]
    s_setprio 3
    s_mov_b64 vcc, s[24:25]
    v_cndmask_b32_dpp v184, v196, v184, vcc row_ror:12 row_mask:0xf bank_mask:0xf
    s_setprio 0
    v_mfma_f32_16x16x32_bf16 v[252:255], v[58:61], v[208:211], v[252:255]
    s_setprio 3
    v_cndmask_b32_dpp v185, v197, v185, vcc row_ror:12 row_mask:0xf bank_mask:0xf
    v_cndmask_b32_dpp v186, v198, v186, vcc row_ror:12 row_mask:0xf bank_mask:0xf
    s_setprio 0
    v_mfma_f32_16x16x32_bf16 v[16:19], v[66:69], v[200:203], 0
    s_setprio 3
    v_cndmask_b32_dpp v187, v199, v187, vcc row_ror:12 row_mask:0xf bank_mask:0xf
    v_mul_f32_dpp v184, v0, v184 quad_perm:[0,0,0,0] row_mask:0xf bank_mask:0xf
    s_setprio 0
    v_mfma_f32_16x16x32_bf16 v[16:19], v[72:75], v[204:207], v[16:19]
    s_setprio 3
    v_cvt_pk_bf16_f32 v230, v252, v253
    v_cvt_pk_bf16_f32 v231, v254, v255
    s_setprio 0
    v_mfma_f32_16x16x32_bf16 v[16:19], v[78:81], v[208:211], v[16:19]
    s_setprio 3
    v_mul_f32_dpp v185, v0, v185 quad_perm:[1,1,1,1] row_mask:0xf bank_mask:0xf
    v_mul_f32_dpp v186, v0, v186 quad_perm:[2,2,2,2] row_mask:0xf bank_mask:0xf
    s_setprio 0
    v_mfma_f32_16x16x32_bf16 v[20:23], v[86:89], v[200:203], 0
    s_setprio 3
    ds_read_b128 v[200:203], v5 offset:12288
    v_mul_f32_dpp v187, v0, v187 quad_perm:[3,3,3,3] row_mask:0xf bank_mask:0xf
    s_setprio 0
    v_mfma_f32_16x16x32_bf16 v[20:23], v[92:95], v[204:207], v[20:23]
    s_setprio 3
    ds_read_b128 v[204:207], v5 offset:13312
    v_cvt_pk_bf16_f32 v236, v16, v17
    s_setprio 0
    v_mfma_f32_16x16x32_bf16 v[20:23], v[98:101], v[208:211], v[20:23]
    s_setprio 3
    ds_read_b128 v[208:211], v5 offset:14336
    v_cvt_pk_bf16_f32 v237, v18, v19
    s_setprio 0
    s_waitcnt lgkmcnt(3)
    v_mfma_f32_16x16x32_bf16 v[248:251], v[26:29], v[212:215], 0
    s_setprio 3
    v_max3_f32 v188, v184, v185, v186
    s_setprio 0
    v_mfma_f32_16x16x32_bf16 v[248:251], v[32:35], v[216:219], v[248:251]
    s_setprio 3
    v_cvt_pk_bf16_f32 v242, v20, v21
    v_cvt_pk_bf16_f32 v243, v22, v23
    s_setprio 0
    v_mfma_f32_16x16x32_bf16 v[248:251], v[38:41], v[220:223], v[248:251]
    s_setprio 3
    v_max_f32 v188, v188, v187
    s_setprio 0
    v_mfma_f32_16x16x32_bf16 v[252:255], v[46:49], v[212:215], 0
    s_setprio 3
    v_mul_f32 v188, -v0, v188
    s_setprio 0
    v_mfma_f32_16x16x32_bf16 v[252:255], v[52:55], v[216:219], v[252:255]
    s_setprio 3
    v_fma_f32 v184, v184, v0, v188
    v_fma_f32 v185, v185, v0, v188
    s_setprio 0
    v_mfma_f32_16x16x32_bf16 v[252:255], v[58:61], v[220:223], v[252:255]
    s_setprio 3
    v_fma_f32 v186, v186, v0, v188
    v_fma_f32 v187, v187, v0, v188
    s_setprio 0
    v_mfma_f32_16x16x32_bf16 v[16:19], v[66:69], v[212:215], 0
    s_setprio 3
    v_exp_f32 v184, v184
    s_setprio 0
    v_mfma_f32_16x16x32_bf16 v[16:19], v[72:75], v[216:219], v[16:19]
    s_setprio 3
    v_exp_f32 v185, v185
    s_setprio 0
    v_mfma_f32_16x16x32_bf16 v[16:19], v[78:81], v[220:223], v[16:19]
    s_setprio 3
    v_exp_f32 v186, v186
    s_setprio 0
    v_mfma_f32_16x16x32_bf16 v[20:23], v[86:89], v[212:215], 0
    s_setprio 3
    ds_read_b128 v[212:215], v5 offset:15360
    v_exp_f32 v187, v187
    s_setprio 0
    v_mfma_f32_16x16x32_bf16 v[20:23], v[92:95], v[216:219], v[20:23]
    s_setprio 3
    ds_read_b128 v[216:219], v5 offset:16384
    v_add_f32 v189, v184, v185
    s_setprio 0
    v_mfma_f32_16x16x32_bf16 v[20:23], v[98:101], v[220:223], v[20:23]
    s_setprio 3
    ds_read_b128 v[220:223], v5 offset:17408
    v_add_f32 v188, v186, v187
    s_setprio 0
    s_waitcnt lgkmcnt(3)
    v_mfma_f32_16x16x32_bf16 v[152:155], v[26:29], v[200:203], 0
    s_setprio 3
    v_add_f32 v189, v189, v188
    v_mul_f32_dpp v184, v0, v184 quad_perm:[0,0,0,0] row_mask:0xf bank_mask:0xf
    s_setprio 0
    v_mfma_f32_16x16x32_bf16 v[152:155], v[32:35], v[204:207], v[152:155]
    s_setprio 3
    v_rcp_f32 v189, v189
    s_setprio 0
    v_mfma_f32_16x16x32_bf16 v[152:155], v[38:41], v[208:211], v[152:155]
    s_setprio 3
    v_mul_f32_dpp v185, v0, v185 quad_perm:[1,1,1,1] row_mask:0xf bank_mask:0xf
    v_mul_f32_dpp v186, v0, v186 quad_perm:[2,2,2,2] row_mask:0xf bank_mask:0xf
    s_setprio 0
    v_mfma_f32_16x16x32_bf16 v[160:163], v[46:49], v[200:203], 0
    s_setprio 3
    v_mul_f32_dpp v187, v0, v187 quad_perm:[3,3,3,3] row_mask:0xf bank_mask:0xf
    v_mul_f32 v184, v184, v189
    s_setprio 0
    v_mfma_f32_16x16x32_bf16 v[160:163], v[52:55], v[204:207], v[160:163]
    s_setprio 3
    v_mul_f32 v185, v185, v189
    v_mul_f32 v186, v186, v189
    s_setprio 0
    v_mfma_f32_16x16x32_bf16 v[160:163], v[58:61], v[208:211], v[160:163]
    s_setprio 3
    v_mul_f32 v187, v187, v189
    v_cvt_pk_bf16_f32 v190, v184, v185
    s_setprio 0
    v_mfma_f32_16x16x32_bf16 v[168:171], v[66:69], v[200:203], 0
    s_setprio 3
    v_cvt_pk_bf16_f32 v191, v186, v187
    v_and_b32 v24, v190, v10
    s_setprio 0
    v_mfma_f32_16x16x32_bf16 v[168:171], v[72:75], v[204:207], v[168:171]
    s_setprio 3
    v_and_b32 v25, v191, v10
    v_cvt_pk_bf16_f32 v228, v248, v249
    s_setprio 0
    v_mfma_f32_16x16x32_bf16 v[168:171], v[78:81], v[208:211], v[168:171]
    s_setprio 3
    v_mov_b64 v[30:31], v[24:25]
    v_cvt_pk_bf16_f32 v229, v250, v251
    s_setprio 0
    v_mfma_f32_16x16x32_bf16 v[176:179], v[86:89], v[200:203], 0
    s_setprio 3
    v_and_b32_dpp v44, v190, v10 row_ror:12 row_mask:0xf bank_mask:0xf
    v_and_b32_dpp v45, v191, v10 row_ror:12 row_mask:0xf bank_mask:0xf
    s_setprio 0
    v_mfma_f32_16x16x32_bf16 v[176:179], v[92:95], v[204:207], v[176:179]
    s_setprio 3
    v_cvt_pk_bf16_f32 v240, v16, v17
    v_cvt_pk_bf16_f32 v241, v18, v19
    s_setprio 0
    v_mfma_f32_16x16x32_bf16 v[176:179], v[98:101], v[208:211], v[176:179]
    s_setprio 3
    v_mov_b64 v[50:51], v[44:45]
    v_cvt_pk_bf16_f32 v234, v252, v253
    s_setprio 0
    s_waitcnt lgkmcnt(0)
    v_mfma_f32_16x16x32_bf16 v[156:159], v[26:29], v[212:215], 0
    s_setprio 3
    v_cvt_pk_bf16_f32 v235, v254, v255
    v_cvt_pk_bf16_f32 v246, v20, v21
    s_setprio 0
    v_mfma_f32_16x16x32_bf16 v[156:159], v[32:35], v[216:219], v[156:159]
    s_setprio 3
    v_cvt_pk_bf16_f32 v247, v22, v23
    v_and_b32_dpp v64, v190, v10 row_ror:8 row_mask:0xf bank_mask:0xf
    s_setprio 0
    v_mfma_f32_16x16x32_bf16 v[156:159], v[38:41], v[220:223], v[156:159]
    s_setprio 3
    v_and_b32_dpp v65, v191, v10 row_ror:8 row_mask:0xf bank_mask:0xf
    v_and_b32_dpp v84, v190, v10 row_ror:4 row_mask:0xf bank_mask:0xf
    s_setprio 0
    v_mfma_f32_16x16x32_bf16 v[164:167], v[46:49], v[212:215], 0
    s_setprio 3
    v_and_b32_dpp v85, v191, v10 row_ror:4 row_mask:0xf bank_mask:0xf
    v_mov_b64 v[70:71], v[64:65]
    s_setprio 0
    v_mfma_f32_16x16x32_bf16 v[164:167], v[52:55], v[216:219], v[164:167]
    s_setprio 3
    v_mov_b64 v[90:91], v[84:85]
    ds_read_b128 v[200:203], v5 offset:18432
    s_setprio 0
    v_mfma_f32_16x16x32_bf16 v[164:167], v[58:61], v[220:223], v[164:167]
    ds_read_b128 v[204:207], v5 offset:19456
    ds_read_b128 v[208:211], v5 offset:20480
    v_mfma_f32_16x16x32_bf16 v[172:175], v[66:69], v[212:215], 0
    s_setprio 3
    v_mov_b64 v[36:37], v[24:25]
    v_mov_b64 v[56:57], v[44:45]
    s_setprio 0
    v_mfma_f32_16x16x32_bf16 v[172:175], v[72:75], v[216:219], v[172:175]
    s_setprio 3
    v_mov_b64 v[76:77], v[64:65]
    v_mov_b64 v[96:97], v[84:85]
    s_setprio 0
    v_mfma_f32_16x16x32_bf16 v[172:175], v[78:81], v[220:223], v[172:175]
    s_setprio 3
    v_mov_b64 v[42:43], v[24:25]
    v_mov_b64 v[62:63], v[44:45]
    s_setprio 0
    v_mfma_f32_16x16x32_bf16 v[180:183], v[86:89], v[212:215], 0
    s_setprio 3
    ds_read_b128 v[212:215], v5 offset:21504
    v_mov_b64 v[82:83], v[64:65]
    s_setprio 0
    v_mfma_f32_16x16x32_bf16 v[180:183], v[92:95], v[216:219], v[180:183]
    s_setprio 3
    ds_read_b128 v[216:219], v5 offset:22528
    v_mov_b64 v[102:103], v[84:85]
    s_setprio 0
    v_mfma_f32_16x16x32_bf16 v[180:183], v[98:101], v[220:223], v[180:183]
    ds_read_b128 v[220:223], v5 offset:23552
    v_mfma_f32_16x16x32_bf16 v[192:195], v[224:227], v[24:27], 0
    s_setprio 3
    v_cvt_pk_bf16_f32 v224, v152, v153
    v_cvt_pk_bf16_f32 v225, v154, v155
    s_setprio 0
    v_mfma_f32_16x16x32_bf16 v[196:199], v[226:229], v[28:31], 0
    s_setprio 3
    v_cvt_pk_bf16_f32 v228, v156, v157
    v_cvt_pk_bf16_f32 v229, v158, v159
    s_setprio 0
    v_mfma_f32_16x16x32_bf16 v[16:19], v[230:233], v[44:47], 0
    s_setprio 3
    v_cvt_pk_bf16_f32 v192, v192, v193
    v_cvt_pk_bf16_f32 v193, v194, v195
    s_setprio 0
    v_mfma_f32_16x16x32_bf16 v[20:23], v[232:235], v[48:51], 0
    s_setprio 3
    v_cvt_pk_bf16_f32 v194, v196, v197
    v_cvt_pk_bf16_f32 v195, v198, v199
    s_setprio 0
    v_mfma_f32_16x16x32_bf16 v[184:187], v[236:239], v[64:67], 0
    ds_write_b128 v1, v[192:195] offset:0
    v_mfma_f32_16x16x32_bf16 v[188:191], v[238:241], v[68:71], 0
    s_setprio 3
    v_cvt_pk_bf16_f32 v16, v16, v17
    v_cvt_pk_bf16_f32 v17, v18, v19
    s_setprio 0
    v_mfma_f32_16x16x32_bf16 v[152:155], v[192:195], v[192:195], 0
    s_setprio 3
    v_cvt_pk_bf16_f32 v18, v20, v21
    v_cvt_pk_bf16_f32 v19, v22, v23
    s_setprio 0
    v_mfma_f32_16x16x32_bf16 v[156:159], v[12:15], v[192:195], 0
    s_setprio 3
    v_cvt_pk_bf16_f32 v230, v160, v161
    v_cvt_pk_bf16_f32 v231, v162, v163
    s_setprio 0
    v_mfma_f32_16x16x32_bf16 v[192:195], v[242:245], v[84:87], 0
    s_setprio 3
    v_cvt_pk_bf16_f32 v234, v164, v165
    v_cvt_pk_bf16_f32 v235, v166, v167
    s_setprio 0
    v_mfma_f32_16x16x32_bf16 v[196:199], v[244:247], v[88:91], 0
    ds_write_b128 v2, v[16:19] offset:768
    v_mfma_f32_16x16x32_bf16 v[160:163], v[16:19], v[16:19], 0
    s_setprio 3
    v_cvt_pk_bf16_f32 v184, v184, v185
    v_cvt_pk_bf16_f32 v185, v186, v187
    s_setprio 0
    v_mfma_f32_16x16x32_bf16 v[164:167], v[12:15], v[16:19], 0
    s_setprio 3
    v_cvt_pk_bf16_f32 v186, v188, v189
    v_cvt_pk_bf16_f32 v187, v190, v191
    s_setprio 0
    v_mfma_f32_16x16x32_bf16 v[16:19], v[224:227], v[30:33], 0
    s_setprio 3
    v_cvt_pk_bf16_f32 v236, v168, v169
    v_cvt_pk_bf16_f32 v237, v170, v171
    s_setprio 0
    v_mfma_f32_16x16x32_bf16 v[20:23], v[226:229], v[34:37], 0
    s_setprio 3
    v_cvt_pk_bf16_f32 v240, v172, v173
    v_cvt_pk_bf16_f32 v241, v174, v175
    s_setprio 0
    v_mfma_f32_16x16x32_bf16 v[168:171], v[184:187], v[184:187], 0
    ds_write_b128 v3, v[184:187] offset:1536
    v_mfma_f32_16x16x32_bf16 v[172:175], v[12:15], v[184:187], 0
    s_setprio 3
    v_cvt_pk_bf16_f32 v192, v192, v193
    v_cvt_pk_bf16_f32 v193, v194, v195
    s_setprio 0
    v_mfma_f32_16x16x32_bf16 v[184:187], v[230:233], v[50:53], 0
    s_setprio 3
    v_cvt_pk_bf16_f32 v194, v196, v197
    v_cvt_pk_bf16_f32 v195, v198, v199
    s_setprio 0
    v_mfma_f32_16x16x32_bf16 v[188:191], v[232:235], v[54:57], 0
    s_setprio 3
    v_cvt_pk_bf16_f32 v242, v176, v177
    v_cvt_pk_bf16_f32 v243, v178, v179
    s_setprio 0
    v_mfma_f32_16x16x32_bf16 v[176:179], v[192:195], v[192:195], 0
    s_setprio 3
    v_cvt_pk_bf16_f32 v246, v180, v181
    v_cvt_pk_bf16_f32 v247, v182, v183
    s_setprio 0
    v_mfma_f32_16x16x32_bf16 v[180:183], v[12:15], v[192:195], 0
    ds_write_b128 v4, v[192:195] offset:2304
    s_waitcnt lgkmcnt(2)
    v_mfma_f32_16x16x32_bf16 v[248:251], v[26:29], v[200:203], 0
    s_setprio 3
    v_cvt_pk_bf16_f32 v16, v16, v17
    v_cvt_pk_bf16_f32 v17, v18, v19
    s_setprio 0
    v_mfma_f32_16x16x32_bf16 v[248:251], v[32:35], v[204:207], v[248:251]
    s_setprio 3
    v_cvt_pk_bf16_f32 v18, v20, v21
    v_cvt_pk_bf16_f32 v19, v22, v23
    s_setprio 0
    v_mfma_f32_16x16x32_bf16 v[248:251], v[38:41], v[208:211], v[248:251]
    ds_write_b128 v1, v[16:19] offset:64
    v_mfma_f32_16x16x32_bf16 v[252:255], v[26:29], v[212:215], 0
    s_setprio 3
    v_cvt_pk_bf16_f32 v184, v184, v185
    v_cvt_pk_bf16_f32 v185, v186, v187
    s_setprio 0
    v_mfma_f32_16x16x32_bf16 v[252:255], v[32:35], v[216:219], v[252:255]
    s_setprio 3
    v_cvt_pk_bf16_f32 v224, v248, v249
    v_cvt_pk_bf16_f32 v225, v250, v251
    s_setprio 0
    v_mfma_f32_16x16x32_bf16 v[252:255], v[38:41], v[220:223], v[252:255]
    s_setprio 3
    v_cvt_pk_bf16_f32 v186, v188, v189
    v_cvt_pk_bf16_f32 v187, v190, v191
    s_setprio 0
    v_mfma_f32_16x16x32_bf16 v[192:195], v[236:239], v[70:73], 0
    ds_write_b128 v2, v[184:187] offset:832
    v_mfma_f32_16x16x32_bf16 v[196:199], v[238:241], v[74:77], 0
    s_setprio 3
    v_cvt_pk_bf16_f32 v228, v252, v253
    v_cvt_pk_bf16_f32 v229, v254, v255
    s_setprio 0
    v_mfma_f32_16x16x32_bf16 v[152:155], v[16:19], v[16:19], v[152:155]
    s_setprio 3
    v_cvt_pk_bf16_f32 v192, v192, v193
    v_cvt_pk_bf16_f32 v193, v194, v195
    s_setprio 0
    v_mfma_f32_16x16x32_bf16 v[156:159], v[12:15], v[16:19], v[156:159]
    s_setprio 3
    v_cvt_pk_bf16_f32 v194, v196, v197
    v_cvt_pk_bf16_f32 v195, v198, v199
    s_setprio 0
    v_mfma_f32_16x16x32_bf16 v[16:19], v[242:245], v[90:93], 0
    ds_write_b128 v3, v[192:195] offset:1600
    v_mfma_f32_16x16x32_bf16 v[20:23], v[244:247], v[94:97], 0
    v_mfma_f32_16x16x32_bf16 v[248:251], v[46:49], v[200:203], 0
    s_setprio 3
    v_cvt_pk_bf16_f32 v16, v16, v17
    v_cvt_pk_bf16_f32 v17, v18, v19
    s_setprio 0
    v_mfma_f32_16x16x32_bf16 v[248:251], v[52:55], v[204:207], v[248:251]
    s_setprio 3
    v_cvt_pk_bf16_f32 v18, v20, v21
    v_cvt_pk_bf16_f32 v19, v22, v23
    s_setprio 0
    v_mfma_f32_16x16x32_bf16 v[248:251], v[58:61], v[208:211], v[248:251]
    ds_write_b128 v4, v[16:19] offset:2368
    v_mfma_f32_16x16x32_bf16 v[252:255], v[46:49], v[212:215], 0
    v_mfma_f32_16x16x32_bf16 v[252:255], v[52:55], v[216:219], v[252:255]
    s_setprio 3
    v_cvt_pk_bf16_f32 v230, v248, v249
    v_cvt_pk_bf16_f32 v231, v250, v251
    s_setprio 0
    v_mfma_f32_16x16x32_bf16 v[252:255], v[58:61], v[220:223], v[252:255]
    v_mfma_f32_16x16x32_bf16 v[160:163], v[184:187], v[184:187], v[160:163]
    v_mfma_f32_16x16x32_bf16 v[164:167], v[12:15], v[184:187], v[164:167]
    s_setprio 3
    v_cvt_pk_bf16_f32 v234, v252, v253
    v_cvt_pk_bf16_f32 v235, v254, v255
    s_setprio 0
    v_mfma_f32_16x16x32_bf16 v[184:187], v[224:227], v[36:39], 0
    v_mfma_f32_16x16x32_bf16 v[188:191], v[226:229], v[40:43], 0
    v_mfma_f32_16x16x32_bf16 v[248:251], v[66:69], v[200:203], 0
    s_setprio 3
    v_cvt_pk_bf16_f32 v184, v184, v185
    v_cvt_pk_bf16_f32 v185, v186, v187
    s_setprio 0
    v_mfma_f32_16x16x32_bf16 v[248:251], v[72:75], v[204:207], v[248:251]
    s_setprio 3
    v_cvt_pk_bf16_f32 v186, v188, v189
    v_cvt_pk_bf16_f32 v187, v190, v191
    s_setprio 0
    v_mfma_f32_16x16x32_bf16 v[248:251], v[78:81], v[208:211], v[248:251]
    ds_write_b128 v1, v[184:187] offset:128
    v_mfma_f32_16x16x32_bf16 v[252:255], v[66:69], v[212:215], 0
    s_setprio 3
    v_add_u32 v1, s34, v1
    s_setprio 0
    v_mfma_f32_16x16x32_bf16 v[252:255], v[72:75], v[216:219], v[252:255]
    s_setprio 3
    v_cvt_pk_bf16_f32 v236, v248, v249
    v_cvt_pk_bf16_f32 v237, v250, v251
    s_setprio 0
    v_mfma_f32_16x16x32_bf16 v[252:255], v[78:81], v[220:223], v[252:255]
    v_mfma_f32_16x16x32_bf16 v[168:171], v[192:195], v[192:195], v[168:171]
    v_mfma_f32_16x16x32_bf16 v[172:175], v[12:15], v[192:195], v[172:175]
    s_setprio 3
    v_cvt_pk_bf16_f32 v240, v252, v253
    v_cvt_pk_bf16_f32 v241, v254, v255
    s_setprio 0
    v_mfma_f32_16x16x32_bf16 v[192:195], v[230:233], v[56:59], 0
    v_mfma_f32_16x16x32_bf16 v[196:199], v[232:235], v[60:63], 0
    v_mfma_f32_16x16x32_bf16 v[248:251], v[86:89], v[200:203], 0
    s_setprio 3
    v_cvt_pk_bf16_f32 v192, v192, v193
    v_cvt_pk_bf16_f32 v193, v194, v195
    s_setprio 0
    v_mfma_f32_16x16x32_bf16 v[248:251], v[92:95], v[204:207], v[248:251]
    s_setprio 3
    v_cvt_pk_bf16_f32 v194, v196, v197
    v_cvt_pk_bf16_f32 v195, v198, v199
    s_setprio 0
    v_mfma_f32_16x16x32_bf16 v[248:251], v[98:101], v[208:211], v[248:251]
    ds_write_b128 v2, v[192:195] offset:896
    v_mfma_f32_16x16x32_bf16 v[252:255], v[86:89], v[212:215], 0
    s_setprio 3
    v_add_u32 v2, s34, v2
    s_setprio 0
    v_mfma_f32_16x16x32_bf16 v[252:255], v[92:95], v[216:219], v[252:255]
    s_setprio 3
    v_cvt_pk_bf16_f32 v242, v248, v249
    v_cvt_pk_bf16_f32 v243, v250, v251
    s_setprio 0
    v_mfma_f32_16x16x32_bf16 v[252:255], v[98:101], v[220:223], v[252:255]
    v_mfma_f32_16x16x32_bf16 v[176:179], v[16:19], v[16:19], v[176:179]
    v_mfma_f32_16x16x32_bf16 v[180:183], v[12:15], v[16:19], v[180:183]
    s_setprio 3
    v_cvt_pk_bf16_f32 v246, v252, v253
    v_cvt_pk_bf16_f32 v247, v254, v255
    s_setprio 0
    v_mfma_f32_16x16x32_bf16 v[16:19], v[236:239], v[76:79], 0
    v_mfma_f32_16x16x32_bf16 v[20:23], v[238:241], v[80:83], 0
    v_mfma_f32_16x16x32_bf16 v[152:155], v[184:187], v[184:187], v[152:155]
    s_setprio 3
    v_cvt_pk_bf16_f32 v16, v16, v17
    v_cvt_pk_bf16_f32 v17, v18, v19
    s_setprio 0
    v_mfma_f32_16x16x32_bf16 v[156:159], v[12:15], v[184:187], v[156:159]
    s_setprio 3
    v_cvt_pk_bf16_f32 v18, v20, v21
    v_cvt_pk_bf16_f32 v19, v22, v23
    s_setprio 0
    v_mfma_f32_16x16x32_bf16 v[184:187], v[242:245], v[96:99], 0
    ds_write_b128 v3, v[16:19] offset:1664
    v_mfma_f32_16x16x32_bf16 v[188:191], v[244:247], v[100:103], 0
    s_setprio 3
    v_add_u32 v3, s34, v3
    s_setprio 0
    v_mfma_f32_16x16x32_bf16 v[160:163], v[192:195], v[192:195], v[160:163]
    s_setprio 3
    v_cvt_pk_bf16_f32 v184, v184, v185
    v_cvt_pk_bf16_f32 v185, v186, v187
    s_setprio 0
    v_mfma_f32_16x16x32_bf16 v[164:167], v[12:15], v[192:195], v[164:167]
    s_setprio 3
    v_cvt_pk_bf16_f32 v186, v188, v189
    v_cvt_pk_bf16_f32 v187, v190, v191
    s_setprio 0
    v_mfma_f32_16x16x32_bf16 v[168:171], v[16:19], v[16:19], v[168:171]
    ds_write_b128 v4, v[184:187] offset:2432
    v_mfma_f32_16x16x32_bf16 v[172:175], v[12:15], v[16:19], v[172:175]
    s_lshl_b64 exec, 1, s16
    ds_inc_u32 v5, v5 offset:63748
    s_mov_b64 exec, -1
    v_mfma_f32_16x16x32_bf16 v[176:179], v[184:187], v[184:187], v[176:179]
    s_setprio 3
    v_add_u32 v4, s34, v4
    s_setprio 0
    v_mfma_f32_16x16x32_bf16 v[180:183], v[12:15], v[184:187], v[180:183]
    s_setprio 3
    s_sub_u32 s35, s35, s34
    s_sub_u32 s34, 0, s34
    s_sub_u32 s40, 0, s40
    s_add_u32 s36, s36, 1
    s_add_u32 s17, s17, 1
    s_cmp_lt_u32 s17, 9
    s_cbranch_scc1 L_Tloop
    v_cndmask_b32 v152, v152, v153, s[28:29]
    v_cndmask_b32 v160, v160, v161, s[28:29]
    v_cndmask_b32 v168, v168, v169, s[28:29]
    v_cndmask_b32 v176, v176, v177, s[28:29]
    v_cndmask_b32 v152, v152, v154, s[30:31]
    v_cndmask_b32 v160, v160, v162, s[30:31]
    v_cndmask_b32 v168, v168, v170, s[30:31]
    v_cndmask_b32 v176, v176, v178, s[30:31]
    v_cndmask_b32 v152, v152, v155, s[32:33]
    v_cndmask_b32 v160, v160, v163, s[32:33]
    v_cndmask_b32 v168, v168, v171, s[32:33]
    v_cndmask_b32 v176, v176, v179, s[32:33]
    s_mov_b64 vcc, s[20:21]
    v_cndmask_b32_dpp v156, v164, v156, vcc row_ror:4 row_mask:0xf bank_mask:0xf
    v_cndmask_b32_dpp v152, v160, v152, vcc row_ror:4 row_mask:0xf bank_mask:0xf
    s_mov_b64 vcc, s[22:23]
    v_cndmask_b32_dpp v156, v172, v156, vcc row_ror:8 row_mask:0xf bank_mask:0xf
    v_cndmask_b32_dpp v152, v168, v152, vcc row_ror:8 row_mask:0xf bank_mask:0xf
    s_mov_b64 vcc, s[24:25]
    v_cndmask_b32_dpp v156, v180, v156, vcc row_ror:12 row_mask:0xf bank_mask:0xf
    v_cndmask_b32_dpp v152, v176, v152, vcc row_ror:12 row_mask:0xf bank_mask:0xf
    v_mul_f32 v156, 0x3c2aaaab, v156
    v_fma_f32 v156, -v156, v156, s42
    v_fmamk_f32 v152, v152, 0x3c2aaaab, v156
    v_max_f32 v152, s42, v152
    v_rsq_f32 v153, v152
    ds_write_b32 v6, v153 offset:0
    s_lshl_b64 exec, 1, s16
    ds_inc_u32 v5, v5 offset:63748
    s_mov_b64 exec, -1
    v_add_u32 v6, s40, v6
    s_endpgm
L_Tc_slow:
    s_mov_b32 s19, 0x100000
L_Tc_sl:
    ds_read_b32 v11, v5 offset:63744
    s_waitcnt lgkmcnt(0)
    s_sub_u32 s19, s19, 1
    s_cbranch_scc1 L_Tc_back
    v_cmp_le_u32 vcc, s36, v11
    s_nop 0
    s_and_b32 s41, vcc_lo, 15
    s_cmp_lg_u32 s41, 15
    s_cbranch_scc1 L_Tc_sl
L_Tc_up:
    s_branch L_Tc_back
L_S:
    s_setprio 0
    s_mov_b32 s97, 9
    v_mov_b32 v19, v0
    s_waitcnt vmcnt(0)
    s_sub_u32 s16, s16, 4
    v_mov_b32 v26, v4
    s_mul_i32 s35, s16, 12288
    s_mul_i32 s39, s16, 28311552
    v_lshlrev_b32 v2, 4, v19
    v_add_u32 v2, 98304, v2
    v_and_b32 v20, 3, v19
    v_bfe_u32 v21, v19, 2, 2
    v_lshrrev_b32 v22, 4, v19
    v_and_b32 v23, 1, v21
    v_lshlrev_b32 v23, 1, v23
    v_xor_b32 v21, v21, v23
    v_and_b32 v23, 1, v21
    v_lshl_or_b32 v23, v23, 2, v20
    v_mul_u32_u24 v23, 192, v23
    v_lshrrev_b32 v24, 1, v21
    v_mul_u32_u24 v24, 73728, v24
    v_add3_u32 v4, v23, v24, s39
    v_lshl_add_u32 v4, v22, 4, v4
    s_mul_i32 s19, s16, 288
    s_add_u32 s19, s19, 159744
    v_and_b32 v23, 1, v22
    v_lshlrev_b32 v23, 1, v23
    v_xor_b32 v23, v22, v23
    v_lshl_add_u32 v3, v23, 4, s19
    v_lshl_or_b32 v23, v21, 2, v20
    v_lshl_add_u32 v5, v23, 2, s19
    v_mul_u32_u24 v23, 192, v23
    v_xor_b32 v22, v22, v21
    v_xor_b32 v22, s16, v22
    v_and_b32 v22, 3, v22
    v_lshl_add_u32 v23, v22, 4, v23
    v_add_u32 v0, s35, v23
    v_and_b32 v20, 3, v19
    v_and_b32 v23, 1, v19
    v_lshlrev_b32 v23, 4, v23
    v_mov_b32 v24, 0x3f80
    v_lshlrev_b32 v23, v23, v24
    v_cmp_gt_u32 vcc, 2, v20
    s_nop 1
    v_cndmask_b32 v6, 0, v23, vcc
    v_cndmask_b32 v7, v23, 0, vcc
    s_mov_b32 s43, 2
    s_mov_b32 s22, 3
    s_mov_b32 s24, 0x7000000
    s_mov_b32 s25, 0x7000000
    s_mov_b32 s40, 1152
    s_mov_b32 s19, 0x100000
L_Sw:
    ds_read_b32 v27, v26 offset:12
    s_sub_u32 s19, s19, 1
    s_cbranch_scc1 L_Sw_x
    s_waitcnt lgkmcnt(0)
    v_cmp_le_u32 vcc, 4, v27
    s_nop 0
    s_cbranch_vccz L_Sw
L_Sw_x:
    ds_read_b128 v[232:235], v2 offset:24576
    ds_read_b128 v[236:239], v2 offset:25600
    ds_read_b128 v[240:243], v2 offset:26624
    ds_read_b128 v[244:247], v2 offset:27648
    ds_read_b128 v[248:251], v2 offset:28672
    ds_read_b128 v[252:255], v2 offset:29696
    ds_read_b128 v[220:223], v2 offset:30720
    ds_read_b128 v[224:227], v2 offset:31744
    ds_read_b128 v[228:231], v2 offset:32768
    ds_read_b128 v[148:151], v2 offset:33792
    ds_read_b128 v[152:155], v2 offset:34816
    ds_read_b128 v[164:167], v2 offset:35840
    ds_read_b128 v[168:171], v2 offset:36864
    ds_read_b128 v[204:207], v2 offset:37888
    ds_read_b128 v[208:211], v2 offset:38912
    ds_read_b128 v[212:215], v2 offset:39936
    ds_read_b128 v[216:219], v2 offset:40960
    ds_read_b128 v[88:91], v2 offset:41984
    ds_read_b32 v8, v2 offset:63748
    s_mul_i32 s19, s18, 43691
    s_lshr_b32 s19, s19, 21
    s_mul_i32 s20, s19, 516096
    s_mul_i32 s19, s18, 1536
    s_add_u32 s20, s20, s19
    s_setprio 1
    s_waitcnt lgkmcnt(0)
L_Sloop:
    v_mfma_f32_16x16x32_bf16 v[196:199], v[108:111], v[156:159], v[196:199]
    s_waitcnt lgkmcnt(0)
    v_cmp_le_u32 vcc, s43, v8
    s_nop 0
    s_and_b32 s41, vcc_lo, 15
    s_cmp_lg_u32 s41, 15
    s_cbranch_scc1 L_Sx_slow
L_Sx_back:
    v_mfma_f32_16x16x32_bf16 v[196:199], v[112:115], v[160:163], v[196:199]
    ds_read_b128 v[44:47], v0 offset:6144
    ds_read_b128 v[48:51], v0 offset:6208
    v_mfma_f32_16x16x32_bf16 v[200:203], v[116:119], v[156:159], v[200:203]
    ds_read_b128 v[52:55], v0 offset:6272
    ds_read_b128 v[56:59], v0 offset:9216
    v_mfma_f32_16x16x32_bf16 v[200:203], v[120:123], v[160:163], v[200:203]
    ds_read_b128 v[60:63], v0 offset:9280
    ds_read_b128 v[64:67], v0 offset:9344
    v_mfma_f32_16x16x32_bf16 v[172:175], v[124:127], v[140:143], v[172:175]
    ds_read_b128 v[20:23], v0 offset:0
    ds_read_b128 v[24:27], v0 offset:64
    v_mfma_f32_16x16x32_bf16 v[172:175], v[128:131], v[144:147], v[172:175]
    ds_read_b128 v[28:31], v0 offset:128
    ds_read_b128 v[32:35], v0 offset:3072
    v_mfma_f32_16x16x32_bf16 v[176:179], v[132:135], v[140:143], v[176:179]
    ds_read_b128 v[36:39], v0 offset:3136
    ds_read_b128 v[40:43], v0 offset:3200
    v_mfma_f32_16x16x32_bf16 v[176:179], v[136:139], v[144:147], v[176:179]
    v_cvt_pk_bf16_f32 v182, v184, v185
    v_cvt_pk_bf16_f32 v183, v186, v187
    v_mfma_f32_16x16x32_bf16 v[188:191], v[124:127], v[156:159], v[188:191]
    v_cvt_pk_bf16_f32 v196, v196, v197
    buffer_store_dwordx4 v[180:183], v4, s[8:11], s24 offen offset:64
    v_mfma_f32_16x16x32_bf16 v[188:191], v[128:131], v[160:163], v[188:191]
    v_cvt_pk_bf16_f32 v197, v198, v199
    v_cvt_pk_bf16_f32 v198, v200, v201
    v_mfma_f32_16x16x32_bf16 v[192:195], v[132:135], v[156:159], v[192:195]
    v_cvt_pk_bf16_f32 v199, v202, v203
    v_cvt_pk_bf16_f32 v172, v172, v173
    v_mfma_f32_16x16x32_bf16 v[192:195], v[136:139], v[160:163], v[192:195]
    buffer_store_dwordx4 v[196:199], v4, s[8:11], s25 offen offset:64
    v_cvt_pk_bf16_f32 v173, v174, v175
    v_cvt_pk_bf16_f32 v174, v176, v177
    v_cvt_pk_bf16_f32 v175, v178, v179
    buffer_store_dwordx4 v[172:175], v4, s[8:11], s24 offen offset:128
    v_cvt_pk_bf16_f32 v188, v188, v189
    v_cvt_pk_bf16_f32 v189, v190, v191
    s_waitcnt lgkmcnt(4)
    v_mfma_f32_16x16x32_bf16 v[92:95], v[232:235], v[44:47], 0
    v_cvt_pk_bf16_f32 v190, v192, v193
    v_cvt_pk_bf16_f32 v191, v194, v195
    v_mfma_f32_16x16x32_bf16 v[92:95], v[236:239], v[48:51], v[92:95]
    buffer_store_dwordx4 v[188:191], v4, s[8:11], s25 offen offset:128
    v_mfma_f32_16x16x32_bf16 v[92:95], v[240:243], v[52:55], v[92:95]
    v_add_u32 v0, s34, v0
    s_sub_u32 s34, 0, s34
    v_mfma_f32_16x16x32_bf16 v[96:99], v[244:247], v[44:47], 0
    s_add_u32 s43, s43, 2
    s_add_u32 s25, s20, 147456
    v_mfma_f32_16x16x32_bf16 v[96:99], v[248:251], v[48:51], v[96:99]
    v_cvt_pk_bf16_f32 v68, v92, v93
    v_cvt_pk_bf16_f32 v69, v94, v95
    v_mfma_f32_16x16x32_bf16 v[96:99], v[252:255], v[52:55], v[96:99]
    s_add_u32 s26, s20, 294912
    s_add_u32 s27, s20, 442368
    v_mfma_f32_16x16x32_bf16 v[100:103], v[220:223], v[44:47], 0
    s_add_u32 s18, s18, 256
    s_mul_i32 s19, s18, 43691
    v_mfma_f32_16x16x32_bf16 v[100:103], v[224:227], v[48:51], v[100:103]
    v_cvt_pk_bf16_f32 v70, v96, v97
    v_cvt_pk_bf16_f32 v71, v98, v99
    v_mfma_f32_16x16x32_bf16 v[100:103], v[228:231], v[52:55], v[100:103]
    s_mov_b32 s24, s20
    s_lshr_b32 s19, s19, 21
    v_mfma_f32_16x16x32_bf16 v[104:107], v[148:151], v[44:47], 0
    s_mul_i32 s20, s19, 516096
    s_mul_i32 s19, s18, 1536
    v_mfma_f32_16x16x32_bf16 v[104:107], v[152:155], v[48:51], v[104:107]
    v_cvt_pk_bf16_f32 v72, v100, v101
    v_cvt_pk_bf16_f32 v73, v102, v103
    v_mfma_f32_16x16x32_bf16 v[104:107], v[164:167], v[52:55], v[104:107]
    s_add_u32 s20, s20, s19
    s_add_u32 s17, s17, 1
    v_mfma_f32_16x16x32_bf16 v[108:111], v[168:171], v[44:47], 0
    s_waitcnt lgkmcnt(0)
    s_lshl_b64 exec, 1, s16
    ds_inc_u32 v2, v2 offset:63744
    s_mov_b64 exec, -1
    v_mfma_f32_16x16x32_bf16 v[108:111], v[204:207], v[48:51], v[108:111]
    v_cvt_pk_bf16_f32 v74, v104, v105
    v_cvt_pk_bf16_f32 v75, v106, v107
    v_mfma_f32_16x16x32_bf16 v[108:111], v[208:211], v[52:55], v[108:111]
    v_mfma_f32_16x16x32_bf16 v[112:115], v[212:215], v[44:47], 0
    v_mfma_f32_16x16x32_bf16 v[112:115], v[216:219], v[48:51], v[112:115]
    v_cvt_pk_bf16_f32 v76, v108, v109
    v_cvt_pk_bf16_f32 v77, v110, v111
    v_mfma_f32_16x16x32_bf16 v[112:115], v[88:91], v[52:55], v[112:115]
    v_mfma_f32_16x16x32_bf16 v[116:119], v[232:235], v[56:59], 0
    v_mfma_f32_16x16x32_bf16 v[116:119], v[236:239], v[60:63], v[116:119]
    v_cvt_pk_bf16_f32 v78, v112, v113
    v_cvt_pk_bf16_f32 v79, v114, v115
    v_mfma_f32_16x16x32_bf16 v[116:119], v[240:243], v[64:67], v[116:119]
    ds_read_b32 v8, v2 offset:63748
    v_mfma_f32_16x16x32_bf16 v[120:123], v[244:247], v[56:59], 0
    v_mfma_f32_16x16x32_bf16 v[120:123], v[248:251], v[60:63], v[120:123]
    v_cvt_pk_bf16_f32 v80, v116, v117
    v_cvt_pk_bf16_f32 v81, v118, v119
    v_mfma_f32_16x16x32_bf16 v[120:123], v[252:255], v[64:67], v[120:123]
    v_mfma_f32_16x16x32_bf16 v[124:127], v[220:223], v[56:59], 0
    v_mfma_f32_16x16x32_bf16 v[124:127], v[224:227], v[60:63], v[124:127]
    v_cvt_pk_bf16_f32 v82, v120, v121
    v_cvt_pk_bf16_f32 v83, v122, v123
    v_mfma_f32_16x16x32_bf16 v[124:127], v[228:231], v[64:67], v[124:127]
    v_mfma_f32_16x16x32_bf16 v[128:131], v[148:151], v[56:59], 0
    v_mfma_f32_16x16x32_bf16 v[128:131], v[152:155], v[60:63], v[128:131]
    v_cvt_pk_bf16_f32 v84, v124, v125
    v_cvt_pk_bf16_f32 v85, v126, v127
    v_mfma_f32_16x16x32_bf16 v[128:131], v[164:167], v[64:67], v[128:131]
    v_mfma_f32_16x16x32_bf16 v[132:135], v[168:171], v[56:59], 0
    v_mfma_f32_16x16x32_bf16 v[132:135], v[204:207], v[60:63], v[132:135]
    v_cvt_pk_bf16_f32 v86, v128, v129
    v_cvt_pk_bf16_f32 v87, v130, v131
    v_mfma_f32_16x16x32_bf16 v[132:135], v[208:211], v[64:67], v[132:135]
    v_mfma_f32_16x16x32_bf16 v[136:139], v[212:215], v[56:59], 0
    s_waitcnt lgkmcnt(0)
    v_cmp_le_u32 vcc, s22, v8
    s_nop 0
    s_and_b32 s41, vcc_lo, 15
    s_cmp_lg_u32 s41, 15
    s_cbranch_scc1 L_Sc_slow
L_Sc_back:
    v_mfma_f32_16x16x32_bf16 v[136:139], v[216:219], v[60:63], v[136:139]
    ds_read_b128 v[204:207], v3 offset:0
    ds_read_b128 v[208:211], v3 offset:64
    v_mfma_f32_16x16x32_bf16 v[136:139], v[88:91], v[64:67], v[136:139]
    v_cvt_pk_bf16_f32 v88, v132, v133
    v_cvt_pk_bf16_f32 v89, v134, v135
    v_mfma_f32_16x16x32_bf16 v[172:175], v[20:23], v[68:71], 0
    ds_read_b128 v[212:215], v3 offset:128
    ds_read_b128 v[216:219], v3 offset:192
    v_mfma_f32_16x16x32_bf16 v[172:175], v[24:27], v[72:75], v[172:175]
    v_cvt_pk_bf16_f32 v90, v136, v137
    v_cvt_pk_bf16_f32 v91, v138, v139
    v_mfma_f32_16x16x32_bf16 v[172:175], v[28:31], v[76:79], v[172:175]
    ds_read2_b32 v[18:19], v5 offset0:32 offset1:48
    ds_read2_b32 v[16:17], v5 offset0:0 offset1:16
    v_mfma_f32_16x16x32_bf16 v[176:179], v[32:35], v[68:71], 0
    v_add_u32 v5, s40, v5
    v_add_u32 v3, s40, v3
    v_mfma_f32_16x16x32_bf16 v[176:179], v[36:39], v[72:75], v[176:179]
    s_sub_u32 s40, 0, s40
    s_add_u32 s22, s22, 2
    v_mfma_f32_16x16x32_bf16 v[176:179], v[40:43], v[76:79], v[176:179]
    v_mfma_f32_16x16x32_bf16 v[180:183], v[44:47], v[68:71], 0
    v_mfma_f32_16x16x32_bf16 v[180:183], v[48:51], v[72:75], v[180:183]
    v_mfma_f32_16x16x32_bf16 v[180:183], v[52:55], v[76:79], v[180:183]
    v_mfma_f32_16x16x32_bf16 v[184:187], v[56:59], v[68:71], 0
    v_mfma_f32_16x16x32_bf16 v[184:187], v[60:63], v[72:75], v[184:187]
    v_mfma_f32_16x16x32_bf16 v[184:187], v[64:67], v[76:79], v[184:187]
    s_waitcnt lgkmcnt(0)
    v_mul_f32 v172, v172, v204
    v_mul_f32 v173, v173, v205
    v_mfma_f32_16x16x32_bf16 v[188:191], v[20:23], v[80:83], 0
    v_mul_f32 v174, v174, v206
    v_mul_f32 v175, v175, v207
    v_mfma_f32_16x16x32_bf16 v[188:191], v[24:27], v[84:87], v[188:191]
    v_mul_f32 v176, v176, v208
    v_max3_f32 v8, v172, v173, v174
    v_mfma_f32_16x16x32_bf16 v[188:191], v[28:31], v[88:91], v[188:191]
    v_mul_f32 v177, v177, v209
    v_mul_f32 v178, v178, v210
    v_mfma_f32_16x16x32_bf16 v[192:195], v[32:35], v[80:83], 0
    v_max3_f32 v8, v8, v175, v176
    v_mul_f32 v179, v179, v211
    v_mfma_f32_16x16x32_bf16 v[192:195], v[36:39], v[84:87], v[192:195]
    v_mul_f32 v188, v188, v204
    v_mul_f32 v189, v189, v205
    v_mfma_f32_16x16x32_bf16 v[192:195], v[40:43], v[88:91], v[192:195]
    v_mul_f32 v190, v190, v206
    v_mul_f32 v191, v191, v207
    v_mfma_f32_16x16x32_bf16 v[196:199], v[44:47], v[80:83], 0
    v_max3_f32 v9, v188, v189, v190
    v_mul_f32 v180, v180, v212
    v_mfma_f32_16x16x32_bf16 v[196:199], v[48:51], v[84:87], v[196:199]
    v_mul_f32 v192, v192, v208
    v_mul_f32 v193, v193, v209
    v_mfma_f32_16x16x32_bf16 v[196:199], v[52:55], v[88:91], v[196:199]
    v_mul_f32 v194, v194, v210
    v_max3_f32 v9, v9, v191, v192
    v_mfma_f32_16x16x32_bf16 v[200:203], v[56:59], v[80:83], 0
    v_mul_f32 v195, v195, v211
    v_max3_f32 v8, v8, v177, v178
    v_mfma_f32_16x16x32_bf16 v[200:203], v[60:63], v[84:87], v[200:203]
    v_mul_f32 v196, v196, v212
    v_max3_f32 v9, v9, v193, v194
    v_mfma_f32_16x16x32_bf16 v[200:203], v[64:67], v[88:91], v[200:203]
    v_mul_f32 v181, v181, v213
    v_mul_f32 v182, v182, v214
    v_mfma_f32_16x16x32_bf16 v[92:95], v[232:235], v[20:23], 0
    v_mul_f32 v197, v197, v213
    v_mul_f32 v198, v198, v214
    v_max3_f32 v8, v8, v179, v180
    v_mfma_f32_16x16x32_bf16 v[92:95], v[236:239], v[24:27], v[92:95]
    v_max3_f32 v9, v9, v195, v196
    v_mul_f32 v183, v183, v215
    v_mul_f32 v184, v184, v216
    v_mfma_f32_16x16x32_bf16 v[92:95], v[240:243], v[28:31], v[92:95]
    v_mul_f32 v199, v199, v215
    v_mul_f32 v200, v200, v216
    v_max3_f32 v8, v8, v181, v182
    v_mfma_f32_16x16x32_bf16 v[116:119], v[232:235], v[32:35], 0
    ds_read_b128 v[232:235], v2 offset:46080
    v_max3_f32 v9, v9, v197, v198
    v_mul_f32 v185, v185, v217
    v_mfma_f32_16x16x32_bf16 v[116:119], v[236:239], v[36:39], v[116:119]
    ds_read_b128 v[236:239], v2 offset:37888
    v_cvt_pk_bf16_f32 v68, v92, v93
    v_cvt_pk_bf16_f32 v69, v94, v95
    v_mfma_f32_16x16x32_bf16 v[116:119], v[240:243], v[40:43], v[116:119]
    ds_read_b128 v[240:243], v2 offset:38912
    v_mul_f32 v186, v186, v218
    v_mul_f32 v201, v201, v217
    v_mfma_f32_16x16x32_bf16 v[96:99], v[244:247], v[20:23], 0
    v_mul_f32 v202, v202, v218
    v_max3_f32 v8, v8, v183, v184
    v_max3_f32 v9, v9, v199, v200
    v_mfma_f32_16x16x32_bf16 v[96:99], v[248:251], v[24:27], v[96:99]
    v_cvt_pk_bf16_f32 v80, v116, v117
    v_cvt_pk_bf16_f32 v81, v118, v119
    v_mul_f32 v187, v187, v219
    v_mfma_f32_16x16x32_bf16 v[96:99], v[252:255], v[28:31], v[96:99]
    v_mul_f32 v203, v203, v219
    v_max3_f32 v8, v8, v185, v186
    v_max3_f32 v9, v9, v201, v202
    v_mfma_f32_16x16x32_bf16 v[120:123], v[244:247], v[32:35], 0
    ds_read_b128 v[244:247], v2 offset:39936
    v_max_f32 v8, v8, v187
    v_max_f32 v9, v9, v203
    v_mfma_f32_16x16x32_bf16 v[120:123], v[248:251], v[36:39], v[120:123]
    ds_read_b128 v[248:251], v2 offset:40960
    v_cvt_pk_bf16_f32 v70, v96, v97
    v_cvt_pk_bf16_f32 v71, v98, v99
    v_mfma_f32_16x16x32_bf16 v[120:123], v[252:255], v[40:43], v[120:123]
    ds_read_b128 v[252:255], v2 offset:41984
    v_permlane32_swap_b32 v8, v9
    v_mfma_f32_16x16x32_bf16 v[100:103], v[220:223], v[20:23], 0
    v_max_f32 v8, v8, v9
    v_mov_b32 v9, v8
    v_mfma_f32_16x16x32_bf16 v[100:103], v[224:227], v[24:27], v[100:103]
    v_cvt_pk_bf16_f32 v82, v120, v121
    v_cvt_pk_bf16_f32 v83, v122, v123
    v_permlane16_swap_b32 v8, v9
    v_mfma_f32_16x16x32_bf16 v[100:103], v[228:231], v[28:31], v[100:103]
    v_max_f32 v8, v8, v9
    v_mov_b32 v9, v8
    v_mfma_f32_16x16x32_bf16 v[124:127], v[220:223], v[32:35], 0
    ds_read_b128 v[220:223], v2 offset:43008
    v_permlane32_swap_b32 v8, v9
    v_mfma_f32_16x16x32_bf16 v[124:127], v[224:227], v[36:39], v[124:127]
    v_cvt_pk_bf16_f32 v72, v100, v101
    v_cvt_pk_bf16_f32 v73, v102, v103
    ds_read_b128 v[224:227], v2 offset:44032
    v_mfma_f32_16x16x32_bf16 v[124:127], v[228:231], v[40:43], v[124:127]
    ds_read_b128 v[228:231], v2 offset:45056
    v_mul_f32 v8, -v18, v8
    v_mul_f32 v9, -v19, v9
    v_mfma_f32_16x16x32_bf16 v[104:107], v[148:151], v[20:23], 0
    v_fma_f32 v172, v172, v18, v8
    v_fma_f32 v188, v188, v19, v9
    v_fma_f32 v173, v173, v18, v8
    v_mfma_f32_16x16x32_bf16 v[104:107], v[152:155], v[24:27], v[104:107]
    v_cvt_pk_bf16_f32 v84, v124, v125
    v_cvt_pk_bf16_f32 v85, v126, v127
    v_fma_f32 v189, v189, v19, v9
    v_mfma_f32_16x16x32_bf16 v[104:107], v[164:167], v[28:31], v[104:107]
    v_exp_f32 v172, v172
    v_exp_f32 v188, v188
    v_mfma_f32_16x16x32_bf16 v[128:131], v[148:151], v[32:35], 0
    v_exp_f32 v173, v173
    v_exp_f32 v189, v189
    v_mfma_f32_16x16x32_bf16 v[128:131], v[152:155], v[36:39], v[128:131]
    v_cvt_pk_bf16_f32 v74, v104, v105
    v_cvt_pk_bf16_f32 v75, v106, v107
    v_fma_f32 v174, v174, v18, v8
    v_mfma_f32_16x16x32_bf16 v[128:131], v[164:167], v[40:43], v[128:131]
    v_fma_f32 v190, v190, v19, v9
    v_add_f32 v10, v172, v173
    v_add_f32 v11, v188, v189
    v_mfma_f32_16x16x32_bf16 v[108:111], v[168:171], v[20:23], 0
    v_exp_f32 v174, v174
    v_exp_f32 v190, v190
    s_waitcnt lgkmcnt(0)
    v_mfma_f32_16x16x32_bf16 v[108:111], v[236:239], v[24:27], v[108:111]
    v_cvt_pk_bf16_f32 v86, v128, v129
    v_cvt_pk_bf16_f32 v87, v130, v131
    v_fma_f32 v175, v175, v18, v8
    v_mfma_f32_16x16x32_bf16 v[108:111], v[240:243], v[28:31], v[108:111]
    v_fma_f32 v191, v191, v19, v9
    v_add_f32 v10, v10, v174
    v_add_f32 v11, v11, v190
    v_mfma_f32_16x16x32_bf16 v[132:135], v[168:171], v[32:35], 0
    v_exp_f32 v175, v175
    v_exp_f32 v191, v191
    v_mfma_f32_16x16x32_bf16 v[132:135], v[236:239], v[36:39], v[132:135]
    v_cvt_pk_bf16_f32 v76, v108, v109
    v_cvt_pk_bf16_f32 v77, v110, v111
    ds_read_b128 v[236:239], v2 offset:47104
    v_mfma_f32_16x16x32_bf16 v[132:135], v[240:243], v[40:43], v[132:135]
    ds_read_b128 v[240:243], v2 offset:48128
    v_fma_f32 v176, v176, v18, v8
    v_fma_f32 v192, v192, v19, v9
    v_mfma_f32_16x16x32_bf16 v[112:115], v[244:247], v[20:23], 0
    v_add_f32 v10, v10, v175
    v_add_f32 v11, v11, v191
    v_exp_f32 v176, v176
    v_mfma_f32_16x16x32_bf16 v[112:115], v[248:251], v[24:27], v[112:115]
    v_cvt_pk_bf16_f32 v88, v132, v133
    v_cvt_pk_bf16_f32 v89, v134, v135
    v_exp_f32 v192, v192
    v_mfma_f32_16x16x32_bf16 v[112:115], v[252:255], v[28:31], v[112:115]
    v_fma_f32 v177, v177, v18, v8
    v_fma_f32 v193, v193, v19, v9
    v_add_f32 v10, v10, v176
    v_mfma_f32_16x16x32_bf16 v[136:139], v[244:247], v[32:35], 0
    ds_read_b128 v[244:247], v2 offset:49152
    v_add_f32 v11, v11, v192
    v_exp_f32 v177, v177
    v_mfma_f32_16x16x32_bf16 v[136:139], v[248:251], v[36:39], v[136:139]
    v_cvt_pk_bf16_f32 v78, v112, v113
    v_cvt_pk_bf16_f32 v79, v114, v115
    ds_read_b128 v[248:251], v2 offset:50176
    v_mfma_f32_16x16x32_bf16 v[136:139], v[252:255], v[40:43], v[136:139]
    ds_read_b128 v[252:255], v2 offset:51200
    v_exp_f32 v193, v193
    v_mfma_f32_16x16x32_bf16 v[140:143], v[20:23], v[68:71], 0
    v_fma_f32 v178, v178, v18, v8
    v_fma_f32 v194, v194, v19, v9
    v_add_f32 v10, v10, v177
    v_mfma_f32_16x16x32_bf16 v[140:143], v[24:27], v[72:75], v[140:143]
    v_cvt_pk_bf16_f32 v90, v136, v137
    v_cvt_pk_bf16_f32 v91, v138, v139
    v_add_f32 v11, v11, v193
    v_mfma_f32_16x16x32_bf16 v[140:143], v[28:31], v[76:79], v[140:143]
    v_exp_f32 v178, v178
    v_exp_f32 v194, v194
    v_mfma_f32_16x16x32_bf16 v[144:147], v[32:35], v[68:71], 0
    v_fma_f32 v179, v179, v18, v8
    v_fma_f32 v195, v195, v19, v9
    v_add_f32 v10, v10, v178
    v_mfma_f32_16x16x32_bf16 v[144:147], v[36:39], v[72:75], v[144:147]
    v_add_f32 v11, v11, v194
    v_exp_f32 v179, v179
    v_mfma_f32_16x16x32_bf16 v[144:147], v[40:43], v[76:79], v[144:147]
    v_exp_f32 v195, v195
    v_fma_f32 v180, v180, v18, v8
    v_mfma_f32_16x16x32_bf16 v[148:151], v[44:47], v[68:71], 0
    v_fma_f32 v196, v196, v19, v9
    v_add_f32 v10, v10, v179
    v_add_f32 v11, v11, v195
    v_mfma_f32_16x16x32_bf16 v[148:151], v[48:51], v[72:75], v[148:151]
    v_exp_f32 v180, v180
    v_exp_f32 v196, v196
    v_mfma_f32_16x16x32_bf16 v[148:151], v[52:55], v[76:79], v[148:151]
    v_fma_f32 v181, v181, v18, v8
    v_fma_f32 v197, v197, v19, v9
    v_add_f32 v10, v10, v180
    v_mfma_f32_16x16x32_bf16 v[152:155], v[56:59], v[68:71], 0
    v_add_f32 v11, v11, v196
    v_exp_f32 v181, v181
    v_mfma_f32_16x16x32_bf16 v[152:155], v[60:63], v[72:75], v[152:155]
    v_exp_f32 v197, v197
    v_fma_f32 v182, v182, v18, v8
    v_mfma_f32_16x16x32_bf16 v[152:155], v[64:67], v[76:79], v[152:155]
    v_fma_f32 v198, v198, v19, v9
    v_add_f32 v10, v10, v181
    v_add_f32 v11, v11, v197
    v_mfma_f32_16x16x32_bf16 v[156:159], v[20:23], v[80:83], 0
    v_exp_f32 v182, v182
    v_exp_f32 v198, v198
    v_mfma_f32_16x16x32_bf16 v[156:159], v[24:27], v[84:87], v[156:159]
    v_fma_f32 v183, v183, v18, v8
    v_fma_f32 v199, v199, v19, v9
    v_add_f32 v10, v10, v182
    v_mfma_f32_16x16x32_bf16 v[156:159], v[28:31], v[88:91], v[156:159]
    v_add_f32 v11, v11, v198
    v_exp_f32 v183, v183
    v_mfma_f32_16x16x32_bf16 v[160:163], v[32:35], v[80:83], 0
    v_exp_f32 v199, v199
    v_fma_f32 v184, v184, v18, v8
    v_mfma_f32_16x16x32_bf16 v[160:163], v[36:39], v[84:87], v[160:163]
    v_fma_f32 v200, v200, v19, v9
    v_add_f32 v10, v10, v183
    v_add_f32 v11, v11, v199
    v_mfma_f32_16x16x32_bf16 v[160:163], v[40:43], v[88:91], v[160:163]
    v_exp_f32 v184, v184
    v_exp_f32 v200, v200
    v_mfma_f32_16x16x32_bf16 v[164:167], v[44:47], v[80:83], 0
    v_fma_f32 v185, v185, v18, v8
    v_fma_f32 v201, v201, v19, v9
    v_add_f32 v10, v10, v184
    v_mfma_f32_16x16x32_bf16 v[164:167], v[48:51], v[84:87], v[164:167]
    v_add_f32 v11, v11, v200
    v_exp_f32 v185, v185
    v_mfma_f32_16x16x32_bf16 v[164:167], v[52:55], v[88:91], v[164:167]
    v_exp_f32 v201, v201
    v_fma_f32 v186, v186, v18, v8
    v_mfma_f32_16x16x32_bf16 v[168:171], v[56:59], v[80:83], 0
    v_fma_f32 v202, v202, v19, v9
    v_add_f32 v10, v10, v185
    v_add_f32 v11, v11, v201
    v_mfma_f32_16x16x32_bf16 v[168:171], v[60:63], v[84:87], v[168:171]
    v_exp_f32 v186, v186
    v_exp_f32 v202, v202
    v_mfma_f32_16x16x32_bf16 v[168:171], v[64:67], v[88:91], v[168:171]
    v_fma_f32 v187, v187, v18, v8
    v_fma_f32 v203, v203, v19, v9
    v_add_f32 v10, v10, v186
    v_mfma_f32_16x16x32_bf16 v[108:111], v[20:23], v[220:223], 0
    v_add_f32 v11, v11, v202
    v_exp_f32 v187, v187
    v_mfma_f32_16x16x32_bf16 v[108:111], v[24:27], v[224:227], v[108:111]
    v_exp_f32 v203, v203
    v_add_f32 v10, v10, v187
    v_mfma_f32_16x16x32_bf16 v[108:111], v[28:31], v[228:231], v[108:111]
    v_add_f32 v11, v11, v203
    v_mul_f32 v172, v172, v204
    v_mul_f32 v173, v173, v205
    v_mfma_f32_16x16x32_bf16 v[112:115], v[32:35], v[220:223], 0
    v_permlane32_swap_b32 v10, v11
    v_add_f32 v10, v10, v11
    v_mfma_f32_16x16x32_bf16 v[112:115], v[36:39], v[224:227], v[112:115]
    v_mov_b32 v11, v10
    v_mul_f32 v174, v174, v206
    v_mul_f32 v175, v175, v207
    v_mfma_f32_16x16x32_bf16 v[112:115], v[40:43], v[228:231], v[112:115]
    v_permlane16_swap_b32 v10, v11
    v_add_f32 v10, v10, v11
    v_mfma_f32_16x16x32_bf16 v[116:119], v[44:47], v[220:223], 0
    v_rcp_f32 v10, v10
    v_mul_f32 v176, v176, v208
    v_mfma_f32_16x16x32_bf16 v[116:119], v[48:51], v[224:227], v[116:119]
    v_mov_b32 v11, v10
    v_mul_f32 v177, v177, v209
    v_mul_f32 v180, v180, v212
    v_mfma_f32_16x16x32_bf16 v[116:119], v[52:55], v[228:231], v[116:119]
    v_permlane32_swap_b32 v10, v11
    v_mul_f32 v172, v172, v10
    v_mfma_f32_16x16x32_bf16 v[120:123], v[56:59], v[220:223], 0
    ds_read_b128 v[220:223], v2 offset:52224
    v_mul_f32 v173, v173, v10
    v_mul_f32 v181, v181, v213
    v_mfma_f32_16x16x32_bf16 v[120:123], v[60:63], v[224:227], v[120:123]
    ds_read_b128 v[224:227], v2 offset:53248
    v_mul_f32 v182, v182, v214
    v_mul_f32 v183, v183, v215
    v_mfma_f32_16x16x32_bf16 v[120:123], v[64:67], v[228:231], v[120:123]
    ds_read_b128 v[228:231], v2 offset:54272
    v_mul_f32 v174, v174, v10
    v_mul_f32 v175, v175, v10
    v_mfma_f32_16x16x32_bf16 v[124:127], v[20:23], v[232:235], 0
    v_mul_f32 v178, v178, v210
    v_mul_f32 v179, v179, v211
    v_mul_f32 v188, v188, v204
    s_waitcnt lgkmcnt(3)
    v_mfma_f32_16x16x32_bf16 v[124:127], v[24:27], v[236:239], v[124:127]
    v_mul_f32 v189, v189, v205
    v_cvt_pk_bf16_f32 v172, v172, v173
    v_mul_f32 v176, v176, v10
    v_mfma_f32_16x16x32_bf16 v[124:127], v[28:31], v[240:243], v[124:127]
    v_mul_f32 v177, v177, v10
    v_mul_f32 v184, v184, v216
    v_mul_f32 v185, v185, v217
    v_mfma_f32_16x16x32_bf16 v[128:131], v[32:35], v[232:235], 0
    v_mul_f32 v186, v186, v218
    v_mul_f32 v187, v187, v219
    v_mul_f32 v190, v190, v206
    v_mfma_f32_16x16x32_bf16 v[128:131], v[36:39], v[236:239], v[128:131]
    v_cvt_pk_bf16_f32 v100, v124, v125
    v_cvt_pk_bf16_f32 v101, v126, v127
    v_mul_f32 v191, v191, v207
    v_mfma_f32_16x16x32_bf16 v[128:131], v[40:43], v[240:243], v[128:131]
    v_cvt_pk_bf16_f32 v173, v174, v175
    v_mul_f32 v180, v180, v10
    v_mul_f32 v181, v181, v10
    v_mfma_f32_16x16x32_bf16 v[132:135], v[44:47], v[232:235], 0
    v_mul_f32 v182, v182, v10
    v_mul_f32 v183, v183, v10
    v_mul_f32 v192, v192, v208
    v_mfma_f32_16x16x32_bf16 v[132:135], v[48:51], v[236:239], v[132:135]
    v_cvt_pk_bf16_f32 v102, v128, v129
    v_cvt_pk_bf16_f32 v103, v130, v131
    v_mul_f32 v193, v193, v209
    v_mfma_f32_16x16x32_bf16 v[132:135], v[52:55], v[240:243], v[132:135]
    v_cvt_pk_bf16_f32 v174, v176, v177
    v_mul_f32 v178, v178, v10
    v_mul_f32 v179, v179, v10
    v_mfma_f32_16x16x32_bf16 v[136:139], v[56:59], v[232:235], 0
    v_mul_f32 v188, v188, v11
    v_mul_f32 v189, v189, v11
    v_mul_f32 v196, v196, v212
    v_mfma_f32_16x16x32_bf16 v[136:139], v[60:63], v[236:239], v[136:139]
    v_cvt_pk_bf16_f32 v104, v132, v133
    v_cvt_pk_bf16_f32 v105, v134, v135
    v_mul_f32 v197, v197, v213
    v_mfma_f32_16x16x32_bf16 v[136:139], v[64:67], v[240:243], v[136:139]
    v_mul_f32 v198, v198, v214
    v_mul_f32 v199, v199, v215
    v_cvt_pk_bf16_f32 v176, v180, v181
    v_mfma_f32_16x16x32_bf16 v[124:127], v[20:23], v[244:247], 0
    v_cvt_pk_bf16_f32 v177, v182, v183
    v_mul_f32 v184, v184, v10
    v_mul_f32 v185, v185, v10
    v_mul_f32 v186, v186, v10
    v_cvt_pk_bf16_f32 v106, v136, v137
    v_mfma_f32_16x16x32_bf16 v[124:127], v[24:27], v[248:251], v[124:127]
    v_cvt_pk_bf16_f32 v107, v138, v139
    v_mul_f32 v187, v187, v10
    v_mul_f32 v190, v190, v11
    v_mul_f32 v191, v191, v11
    v_mul_f32 v194, v194, v210
    v_mfma_f32_16x16x32_bf16 v[124:127], v[28:31], v[252:255], v[124:127]
    v_mul_f32 v195, v195, v211
    v_cvt_pk_bf16_f32 v175, v178, v179
    v_cvt_pk_bf16_f32 v188, v188, v189
    v_mul_f32 v192, v192, v11
    v_mul_f32 v193, v193, v11
    v_mfma_f32_16x16x32_bf16 v[128:131], v[32:35], v[244:247], 0
    v_mul_f32 v200, v200, v216
    v_mul_f32 v201, v201, v217
    v_mul_f32 v202, v202, v218
    v_mul_f32 v203, v203, v219
    v_cvt_pk_bf16_f32 v178, v184, v185
    v_mfma_f32_16x16x32_bf16 v[128:131], v[36:39], v[248:251], v[128:131]
    v_cvt_pk_bf16_f32 v179, v186, v187
    v_cvt_pk_bf16_f32 v189, v190, v191
    v_mul_f32 v196, v196, v11
    v_mul_f32 v197, v197, v11
    v_mul_f32 v198, v198, v11
    v_mfma_f32_16x16x32_bf16 v[128:131], v[40:43], v[252:255], v[128:131]
    v_mul_f32 v199, v199, v11
    v_cvt_pk_bf16_f32 v190, v192, v193
    v_mul_f32 v194, v194, v11
    v_mul_f32 v195, v195, v11
    v_cvt_pk_bf16_f32 v192, v196, v197
    v_mfma_f32_16x16x32_bf16 v[132:135], v[44:47], v[244:247], 0
    v_cvt_pk_bf16_f32 v193, v198, v199
    v_mul_f32 v200, v200, v11
    v_mul_f32 v201, v201, v11
    v_mul_f32 v202, v202, v11
    v_mul_f32 v203, v203, v11
    v_mfma_f32_16x16x32_bf16 v[132:135], v[48:51], v[248:251], v[132:135]
    v_cvt_pk_bf16_f32 v191, v194, v195
    v_cvt_pk_bf16_f32 v194, v200, v201
    v_cvt_pk_bf16_f32 v195, v202, v203
    v_cvt_pk_bf16_f32 v92, v108, v109
    v_cvt_pk_bf16_f32 v93, v110, v111
    v_mfma_f32_16x16x32_bf16 v[132:135], v[52:55], v[252:255], v[132:135]
    v_cvt_pk_bf16_f32 v94, v112, v113
    v_cvt_pk_bf16_f32 v95, v114, v115
    ds_read_b128 v[232:235], v2 offset:55296
    v_cvt_pk_bf16_f32 v96, v116, v117
    v_cvt_pk_bf16_f32 v97, v118, v119
    v_mfma_f32_16x16x32_bf16 v[136:139], v[56:59], v[244:247], 0
    v_cvt_pk_bf16_f32 v98, v120, v121
    v_cvt_pk_bf16_f32 v99, v122, v123
    ds_read_b128 v[236:239], v2 offset:56320
    ds_read_b128 v[240:243], v2 offset:57344
    ds_read_b128 v[244:247], v2 offset:58368
    v_mfma_f32_16x16x32_bf16 v[136:139], v[60:63], v[248:251], v[136:139]
    ds_read_b128 v[248:251], v2 offset:59392
    v_cvt_pk_bf16_f32 v108, v124, v125
    v_cvt_pk_bf16_f32 v109, v126, v127
    v_cvt_pk_bf16_f32 v110, v128, v129
    v_cvt_pk_bf16_f32 v111, v130, v131
    v_mfma_f32_16x16x32_bf16 v[136:139], v[64:67], v[252:255], v[136:139]
    ds_read_b128 v[252:255], v2 offset:60416
    v_cvt_pk_bf16_f32 v112, v132, v133
    v_cvt_pk_bf16_f32 v113, v134, v135
    v_mul_f32 v140, v140, v204
    v_mul_f32 v141, v141, v205
    s_waitcnt lgkmcnt(6)
    v_mfma_f32_16x16x32_bf16 v[68:71], v[20:23], v[220:223], 0
    v_mul_f32 v142, v142, v206
    v_mul_f32 v156, v156, v204
    v_cvt_pk_bf16_f32 v114, v136, v137
    v_cvt_pk_bf16_f32 v115, v138, v139
    v_mul_f32 v157, v157, v205
    v_mfma_f32_16x16x32_bf16 v[68:71], v[24:27], v[224:227], v[68:71]
    v_mul_f32 v158, v158, v206
    v_mul_f32 v143, v143, v207
    v_mul_f32 v144, v144, v208
    v_mul_f32 v159, v159, v207
    v_mul_f32 v160, v160, v208
    v_mfma_f32_16x16x32_bf16 v[68:71], v[28:31], v[228:231], v[68:71]
    v_max3_f32 v12, v140, v141, v142
    v_max3_f32 v13, v156, v157, v158
    v_mul_f32 v145, v145, v209
    v_mul_f32 v146, v146, v210
    v_mul_f32 v161, v161, v209
    v_mfma_f32_16x16x32_bf16 v[72:75], v[32:35], v[220:223], 0
    v_mul_f32 v162, v162, v210
    v_max3_f32 v12, v12, v143, v144
    v_cvt_pk_bf16_f32 v116, v68, v69
    v_cvt_pk_bf16_f32 v117, v70, v71
    v_max3_f32 v13, v13, v159, v160
    v_mfma_f32_16x16x32_bf16 v[72:75], v[36:39], v[224:227], v[72:75]
    v_mul_f32 v147, v147, v211
    v_mul_f32 v148, v148, v212
    v_mul_f32 v163, v163, v211
    v_mul_f32 v164, v164, v212
    v_max3_f32 v12, v12, v145, v146
    v_mfma_f32_16x16x32_bf16 v[72:75], v[40:43], v[228:231], v[72:75]
    v_max3_f32 v13, v13, v161, v162
    v_mul_f32 v149, v149, v213
    v_mul_f32 v150, v150, v214
    v_mul_f32 v165, v165, v213
    v_mul_f32 v166, v166, v214
    v_mfma_f32_16x16x32_bf16 v[76:79], v[44:47], v[220:223], 0
    v_max3_f32 v12, v12, v147, v148
    v_max3_f32 v13, v13, v163, v164
    v_cvt_pk_bf16_f32 v118, v72, v73
    v_cvt_pk_bf16_f32 v119, v74, v75
    v_mul_f32 v151, v151, v215
    v_mfma_f32_16x16x32_bf16 v[76:79], v[48:51], v[224:227], v[76:79]
    v_mul_f32 v152, v152, v216
    v_mul_f32 v167, v167, v215
    v_mul_f32 v168, v168, v216
    v_max3_f32 v12, v12, v149, v150
    v_max3_f32 v13, v13, v165, v166
    v_mfma_f32_16x16x32_bf16 v[76:79], v[52:55], v[228:231], v[76:79]
    v_mul_f32 v153, v153, v217
    v_mul_f32 v154, v154, v218
    v_mul_f32 v169, v169, v217
    v_mul_f32 v170, v170, v218
    v_max3_f32 v12, v12, v151, v152
    v_mfma_f32_16x16x32_bf16 v[80:83], v[56:59], v[220:223], 0
    ds_read_b128 v[220:223], v2 offset:30720
    v_max3_f32 v13, v13, v167, v168
    v_cvt_pk_bf16_f32 v120, v76, v77
    v_cvt_pk_bf16_f32 v121, v78, v79
    v_mul_f32 v155, v155, v219
    v_mfma_f32_16x16x32_bf16 v[80:83], v[60:63], v[224:227], v[80:83]
    ds_read_b128 v[224:227], v2 offset:31744
    v_mul_f32 v171, v171, v219
    v_max3_f32 v12, v12, v153, v154
    v_max3_f32 v13, v13, v169, v170
    v_max_f32 v12, v12, v155
    v_mfma_f32_16x16x32_bf16 v[80:83], v[64:67], v[228:231], v[80:83]
    ds_read_b128 v[228:231], v2 offset:32768
    v_max_f32 v13, v13, v171
    s_nop 1
    v_permlane32_swap_b32 v12, v13
    v_mfma_f32_4x4x4_16b_bf16 v[180:183], v[6:7], v[44:45], 0
    v_max_f32 v12, v12, v13
    v_mfma_f32_4x4x4_16b_bf16 v[184:187], v[6:7], v[46:47], 0
    v_mov_b32 v13, v12
    v_mfma_f32_4x4x4_16b_bf16 v[196:199], v[6:7], v[56:57], 0
    v_cvt_pk_bf16_f32 v122, v80, v81
    v_mfma_f32_4x4x4_16b_bf16 v[200:203], v[6:7], v[58:59], 0
    v_cvt_pk_bf16_f32 v123, v82, v83
    v_mfma_f32_16x16x32_bf16 v[180:183], v[92:95], v[172:175], v[180:183]
    v_permlane16_swap_b32 v12, v13
    v_max_f32 v12, v12, v13
    v_mov_b32 v13, v12
    v_mfma_f32_16x16x32_bf16 v[180:183], v[96:99], v[176:179], v[180:183]
    s_nop 0
    v_permlane32_swap_b32 v12, v13
    v_mul_f32 v12, -v16, v12
    v_mul_f32 v13, -v17, v13
    v_mfma_f32_16x16x32_bf16 v[184:187], v[100:103], v[172:175], v[184:187]
    v_fma_f32 v140, v140, v16, v12
    v_fma_f32 v156, v156, v17, v13
    v_fma_f32 v141, v141, v16, v12
    v_fma_f32 v157, v157, v17, v13
    v_cvt_pk_bf16_f32 v180, v180, v181
    v_mfma_f32_16x16x32_bf16 v[184:187], v[104:107], v[176:179], v[184:187]
    v_cvt_pk_bf16_f32 v181, v182, v183
    v_exp_f32 v140, v140
    v_exp_f32 v156, v156
    v_mfma_f32_16x16x32_bf16 v[196:199], v[92:95], v[188:191], v[196:199]
    v_exp_f32 v141, v141
    v_exp_f32 v157, v157
    v_fma_f32 v142, v142, v16, v12
    v_mfma_f32_16x16x32_bf16 v[196:199], v[96:99], v[192:195], v[196:199]
    v_cvt_pk_bf16_f32 v182, v184, v185
    v_cvt_pk_bf16_f32 v183, v186, v187
    buffer_store_dwordx4 v[180:183], v4, s[8:11], s26 offen offset:0
    v_fma_f32 v158, v158, v17, v13
    v_mfma_f32_16x16x32_bf16 v[200:203], v[100:103], v[188:191], v[200:203]
    v_add_f32 v14, v140, v141
    v_add_f32 v15, v156, v157
    v_exp_f32 v142, v142
    v_cvt_pk_bf16_f32 v196, v196, v197
    v_mfma_f32_16x16x32_bf16 v[200:203], v[104:107], v[192:195], v[200:203]
    v_cvt_pk_bf16_f32 v197, v198, v199
    v_exp_f32 v158, v158
    v_fma_f32 v143, v143, v16, v12
    v_fma_f32 v159, v159, v17, v13
    s_waitcnt lgkmcnt(0)
    v_mfma_f32_16x16x32_bf16 v[68:71], v[20:23], v[232:235], 0
    v_add_f32 v14, v14, v142
    v_add_f32 v15, v15, v158
    v_exp_f32 v143, v143
    v_cvt_pk_bf16_f32 v198, v200, v201
    v_mfma_f32_16x16x32_bf16 v[68:71], v[24:27], v[236:239], v[68:71]
    v_cvt_pk_bf16_f32 v199, v202, v203
    buffer_store_dwordx4 v[196:199], v4, s[8:11], s27 offen offset:0
    v_exp_f32 v159, v159
    v_mfma_f32_16x16x32_bf16 v[68:71], v[28:31], v[240:243], v[68:71]
    v_fma_f32 v144, v144, v16, v12
    v_fma_f32 v160, v160, v17, v13
    v_add_f32 v14, v14, v143
    v_add_f32 v15, v15, v159
    v_exp_f32 v144, v144
    v_mfma_f32_16x16x32_bf16 v[72:75], v[32:35], v[232:235], 0
    v_exp_f32 v160, v160
    v_fma_f32 v145, v145, v16, v12
    v_cvt_pk_bf16_f32 v124, v68, v69
    v_cvt_pk_bf16_f32 v125, v70, v71
    v_mfma_f32_16x16x32_bf16 v[72:75], v[36:39], v[236:239], v[72:75]
    v_fma_f32 v161, v161, v17, v13
    v_add_f32 v14, v14, v144
    v_add_f32 v15, v15, v160
    v_exp_f32 v145, v145
    v_mfma_f32_16x16x32_bf16 v[72:75], v[40:43], v[240:243], v[72:75]
    v_exp_f32 v161, v161
    v_fma_f32 v146, v146, v16, v12
    v_fma_f32 v162, v162, v17, v13
    v_add_f32 v14, v14, v145
    v_mfma_f32_16x16x32_bf16 v[76:79], v[44:47], v[232:235], 0
    v_add_f32 v15, v15, v161
    v_exp_f32 v146, v146
    v_exp_f32 v162, v162
    v_mfma_f32_16x16x32_bf16 v[76:79], v[48:51], v[236:239], v[76:79]
    v_cvt_pk_bf16_f32 v126, v72, v73
    v_cvt_pk_bf16_f32 v127, v74, v75
    v_fma_f32 v147, v147, v16, v12
    v_fma_f32 v163, v163, v17, v13
    v_add_f32 v14, v14, v146
    v_mfma_f32_16x16x32_bf16 v[76:79], v[52:55], v[240:243], v[76:79]
    v_add_f32 v15, v15, v162
    v_exp_f32 v147, v147
    v_exp_f32 v163, v163
    v_mfma_f32_16x16x32_bf16 v[80:83], v[56:59], v[232:235], 0
    ds_read_b128 v[232:235], v2 offset:24576
    v_fma_f32 v148, v148, v16, v12
    v_fma_f32 v164, v164, v17, v13
    v_add_f32 v14, v14, v147
    v_cvt_pk_bf16_f32 v128, v76, v77
    v_mfma_f32_16x16x32_bf16 v[80:83], v[60:63], v[236:239], v[80:83]
    ds_read_b128 v[236:239], v2 offset:25600
    v_cvt_pk_bf16_f32 v129, v78, v79
    v_add_f32 v15, v15, v163
    v_exp_f32 v148, v148
    v_mfma_f32_16x16x32_bf16 v[80:83], v[64:67], v[240:243], v[80:83]
    ds_read_b128 v[240:243], v2 offset:26624
    v_exp_f32 v164, v164
    v_fma_f32 v149, v149, v16, v12
    v_fma_f32 v165, v165, v17, v13
    v_mfma_f32_16x16x32_bf16 v[84:87], v[20:23], v[244:247], 0
    v_add_f32 v14, v14, v148
    v_add_f32 v15, v15, v164
    v_exp_f32 v149, v149
    v_cvt_pk_bf16_f32 v130, v80, v81
    v_mfma_f32_16x16x32_bf16 v[84:87], v[24:27], v[248:251], v[84:87]
    v_cvt_pk_bf16_f32 v131, v82, v83
    v_exp_f32 v165, v165
    v_fma_f32 v150, v150, v16, v12
    v_fma_f32 v166, v166, v17, v13
    v_mfma_f32_16x16x32_bf16 v[84:87], v[28:31], v[252:255], v[84:87]
    v_add_f32 v14, v14, v149
    v_add_f32 v15, v15, v165
    v_exp_f32 v150, v150
    v_exp_f32 v166, v166
    v_mfma_f32_16x16x32_bf16 v[88:91], v[32:35], v[244:247], 0
    v_fma_f32 v151, v151, v16, v12
    v_fma_f32 v167, v167, v17, v13
    v_add_f32 v14, v14, v150
    v_cvt_pk_bf16_f32 v132, v84, v85
    v_cvt_pk_bf16_f32 v133, v86, v87
    v_mfma_f32_16x16x32_bf16 v[88:91], v[36:39], v[248:251], v[88:91]
    v_add_f32 v15, v15, v166
    v_exp_f32 v151, v151
    v_exp_f32 v167, v167
    v_mfma_f32_16x16x32_bf16 v[88:91], v[40:43], v[252:255], v[88:91]
    v_fma_f32 v152, v152, v16, v12
    v_fma_f32 v168, v168, v17, v13
    v_add_f32 v14, v14, v151
    v_add_f32 v15, v15, v167
    v_exp_f32 v152, v152
    v_mfma_f32_16x16x32_bf16 v[68:71], v[44:47], v[244:247], 0
    v_exp_f32 v168, v168
    v_fma_f32 v153, v153, v16, v12
    v_cvt_pk_bf16_f32 v134, v88, v89
    v_cvt_pk_bf16_f32 v135, v90, v91
    v_mfma_f32_16x16x32_bf16 v[68:71], v[48:51], v[248:251], v[68:71]
    ds_read_b128 v[88:91], v2 offset:41984
    v_fma_f32 v169, v169, v17, v13
    v_add_f32 v14, v14, v152
    v_add_f32 v15, v15, v168
    v_exp_f32 v153, v153
    v_mfma_f32_16x16x32_bf16 v[68:71], v[52:55], v[252:255], v[68:71]
    v_exp_f32 v169, v169
    v_fma_f32 v154, v154, v16, v12
    v_fma_f32 v170, v170, v17, v13
    v_add_f32 v14, v14, v153
    v_mfma_f32_16x16x32_bf16 v[72:75], v[56:59], v[244:247], 0
    ds_read_b128 v[244:247], v2 offset:27648
    v_add_f32 v15, v15, v169
    v_exp_f32 v154, v154
    v_cvt_pk_bf16_f32 v136, v68, v69
    v_mfma_f32_16x16x32_bf16 v[72:75], v[60:63], v[248:251], v[72:75]
    ds_read_b128 v[248:251], v2 offset:28672
    v_cvt_pk_bf16_f32 v137, v70, v71
    v_exp_f32 v170, v170
    v_fma_f32 v155, v155, v16, v12
    v_mfma_f32_16x16x32_bf16 v[72:75], v[64:67], v[252:255], v[72:75]
    ds_read_b128 v[252:255], v2 offset:29696
    v_fma_f32 v171, v171, v17, v13
    v_add_f32 v14, v14, v154
    v_add_f32 v15, v15, v170
    v_exp_f32 v155, v155
    v_mfma_f32_4x4x4_16b_bf16 v[180:183], v[6:7], v[48:49], 0
    v_exp_f32 v171, v171
    v_mfma_f32_4x4x4_16b_bf16 v[184:187], v[6:7], v[50:51], 0
    v_cvt_pk_bf16_f32 v138, v72, v73
    v_mfma_f32_4x4x4_16b_bf16 v[196:199], v[6:7], v[60:61], 0
    v_cvt_pk_bf16_f32 v139, v74, v75
    v_mfma_f32_4x4x4_16b_bf16 v[200:203], v[6:7], v[62:63], 0
    v_add_f32 v14, v14, v155
    v_mfma_f32_16x16x32_bf16 v[180:183], v[108:111], v[172:175], v[180:183]
    v_add_f32 v15, v15, v171
    v_mul_f32 v140, v140, v204
    v_mul_f32 v141, v141, v205
    v_permlane32_swap_b32 v14, v15
    v_mfma_f32_16x16x32_bf16 v[180:183], v[112:115], v[176:179], v[180:183]
    v_add_f32 v14, v14, v15
    v_mul_f32 v142, v142, v206
    v_mov_b32 v15, v14
    v_mul_f32 v143, v143, v207
    v_mul_f32 v144, v144, v208
    v_mfma_f32_16x16x32_bf16 v[184:187], v[116:119], v[172:175], v[184:187]
    v_permlane16_swap_b32 v14, v15
    v_add_f32 v14, v14, v15
    v_cvt_pk_bf16_f32 v180, v180, v181
    v_cvt_pk_bf16_f32 v181, v182, v183
    v_mfma_f32_16x16x32_bf16 v[184:187], v[120:123], v[176:179], v[184:187]
    v_rcp_f32 v14, v14
    v_mul_f32 v145, v145, v209
    v_mov_b32 v15, v14
    v_mul_f32 v146, v146, v210
    v_mfma_f32_16x16x32_bf16 v[196:199], v[108:111], v[188:191], v[196:199]
    v_permlane32_swap_b32 v14, v15
    v_mul_f32 v147, v147, v211
    v_mul_f32 v140, v140, v14
    v_cvt_pk_bf16_f32 v182, v184, v185
    v_mfma_f32_16x16x32_bf16 v[196:199], v[112:115], v[192:195], v[196:199]
    v_cvt_pk_bf16_f32 v183, v186, v187
    buffer_store_dwordx4 v[180:183], v4, s[8:11], s26 offen offset:64
    v_mul_f32 v141, v141, v14
    v_mul_f32 v142, v142, v14
    v_mfma_f32_16x16x32_bf16 v[200:203], v[116:119], v[188:191], v[200:203]
    v_mul_f32 v143, v143, v14
    v_cvt_pk_bf16_f32 v140, v140, v141
    v_mul_f32 v144, v144, v14
    v_cvt_pk_bf16_f32 v196, v196, v197
    v_cvt_pk_bf16_f32 v197, v198, v199
    v_mfma_f32_16x16x32_bf16 v[200:203], v[120:123], v[192:195], v[200:203]
    v_mul_f32 v145, v145, v14
    v_mul_f32 v146, v146, v14
    v_mul_f32 v147, v147, v14
    v_cvt_pk_bf16_f32 v141, v142, v143
    v_mul_f32 v148, v148, v212
    v_mfma_f32_4x4x4_16b_bf16 v[76:79], v[6:7], v[52:53], 0
    v_mul_f32 v149, v149, v213
    v_mfma_f32_4x4x4_16b_bf16 v[80:83], v[6:7], v[54:55], 0
    v_cvt_pk_bf16_f32 v198, v200, v201
    v_mfma_f32_4x4x4_16b_bf16 v[68:71], v[6:7], v[64:65], 0
    v_cvt_pk_bf16_f32 v199, v202, v203
    v_mfma_f32_4x4x4_16b_bf16 v[72:75], v[6:7], v[66:67], 0
    buffer_store_dwordx4 v[196:199], v4, s[8:11], s27 offen offset:64
    v_mfma_f32_16x16x32_bf16 v[76:79], v[124:127], v[172:175], v[76:79]
    v_mul_f32 v150, v150, v214
    v_mul_f32 v151, v151, v215
    v_mul_f32 v152, v152, v216
    v_mul_f32 v153, v153, v217
    v_mul_f32 v154, v154, v218
    v_mfma_f32_16x16x32_bf16 v[76:79], v[128:131], v[176:179], v[76:79]
    v_mul_f32 v155, v155, v219
    v_cvt_pk_bf16_f32 v142, v144, v145
    v_cvt_pk_bf16_f32 v143, v146, v147
    v_mul_f32 v148, v148, v14
    v_mul_f32 v149, v149, v14
    v_mfma_f32_16x16x32_bf16 v[80:83], v[132:135], v[172:175], v[80:83]
    v_mul_f32 v150, v150, v14
    v_mul_f32 v151, v151, v14
    v_cvt_pk_bf16_f32 v76, v76, v77
    v_cvt_pk_bf16_f32 v77, v78, v79
    v_mul_f32 v152, v152, v14
    v_mfma_f32_16x16x32_bf16 v[80:83], v[136:139], v[176:179], v[80:83]
    v_mul_f32 v153, v153, v14
    v_mul_f32 v154, v154, v14
    v_mul_f32 v155, v155, v14
    v_cvt_pk_bf16_f32 v144, v148, v149
    v_cvt_pk_bf16_f32 v145, v150, v151
    v_mfma_f32_16x16x32_bf16 v[68:71], v[124:127], v[188:191], v[68:71]
    ds_read_b128 v[148:151], v2 offset:33792
    v_cvt_pk_bf16_f32 v146, v152, v153
    v_cvt_pk_bf16_f32 v78, v80, v81
    v_cvt_pk_bf16_f32 v79, v82, v83
    buffer_store_dwordx4 v[76:79], v4, s[8:11], s26 offen offset:128
    v_mfma_f32_16x16x32_bf16 v[68:71], v[128:131], v[192:195], v[68:71]
    v_cvt_pk_bf16_f32 v147, v154, v155
    ds_read_b128 v[152:155], v2 offset:34816
    v_mul_f32 v156, v156, v204
    v_mul_f32 v157, v157, v205
    v_mul_f32 v158, v158, v206
    v_mfma_f32_16x16x32_bf16 v[72:75], v[132:135], v[188:191], v[72:75]
    v_mul_f32 v159, v159, v207
    ds_read_b128 v[204:207], v2 offset:37888
    v_cvt_pk_bf16_f32 v68, v68, v69
    v_cvt_pk_bf16_f32 v69, v70, v71
    v_mul_f32 v160, v160, v208
    v_mfma_f32_16x16x32_bf16 v[72:75], v[136:139], v[192:195], v[72:75]
    v_mul_f32 v161, v161, v209
    v_mul_f32 v162, v162, v210
    v_mul_f32 v163, v163, v211
    ds_read_b128 v[208:211], v2 offset:38912
    v_mul_f32 v156, v156, v15
    v_mfma_f32_4x4x4_16b_bf16 v[172:175], v[6:7], v[28:29], 0
    v_mul_f32 v157, v157, v15
    v_mfma_f32_4x4x4_16b_bf16 v[176:179], v[6:7], v[30:31], 0
    v_cvt_pk_bf16_f32 v70, v72, v73
    v_mfma_f32_4x4x4_16b_bf16 v[188:191], v[6:7], v[40:41], 0
    v_cvt_pk_bf16_f32 v71, v74, v75
    v_mfma_f32_4x4x4_16b_bf16 v[192:195], v[6:7], v[42:43], 0
    buffer_store_dwordx4 v[68:71], v4, s[8:11], s27 offen offset:128
    v_mfma_f32_4x4x4_16b_bf16 v[180:183], v[6:7], v[24:25], 0
    v_mul_f32 v158, v158, v15
    v_mfma_f32_4x4x4_16b_bf16 v[184:187], v[6:7], v[26:27], 0
    v_mul_f32 v159, v159, v15
    v_mfma_f32_4x4x4_16b_bf16 v[196:199], v[6:7], v[36:37], 0
    v_cvt_pk_bf16_f32 v156, v156, v157
    v_mfma_f32_4x4x4_16b_bf16 v[200:203], v[6:7], v[38:39], 0
    v_mul_f32 v160, v160, v15
    v_mfma_f32_4x4x4_16b_bf16 v[68:71], v[6:7], v[20:21], 0
    v_mul_f32 v161, v161, v15
    v_mfma_f32_4x4x4_16b_bf16 v[72:75], v[6:7], v[22:23], 0
    v_mul_f32 v162, v162, v15
    v_mfma_f32_4x4x4_16b_bf16 v[76:79], v[6:7], v[32:33], 0
    v_mul_f32 v163, v163, v15
    v_mfma_f32_4x4x4_16b_bf16 v[80:83], v[6:7], v[34:35], 0
    v_cvt_pk_bf16_f32 v157, v158, v159
    v_mfma_f32_16x16x32_bf16 v[68:71], v[92:95], v[140:143], v[68:71]
    v_mul_f32 v164, v164, v212
    v_mul_f32 v165, v165, v213
    v_mfma_f32_16x16x32_bf16 v[68:71], v[96:99], v[144:147], v[68:71]
    v_mul_f32 v166, v166, v214
    v_mul_f32 v167, v167, v215
    v_mfma_f32_16x16x32_bf16 v[72:75], v[100:103], v[140:143], v[72:75]
    ds_read_b128 v[212:215], v2 offset:39936
    v_mul_f32 v168, v168, v216
    v_mfma_f32_16x16x32_bf16 v[72:75], v[104:107], v[144:147], v[72:75]
    v_mul_f32 v169, v169, v217
    v_mul_f32 v170, v170, v218
    v_mul_f32 v171, v171, v219
    ds_read_b128 v[216:219], v2 offset:40960
    v_cvt_pk_bf16_f32 v158, v160, v161
    v_cvt_pk_bf16_f32 v159, v162, v163
    v_mul_f32 v164, v164, v15
    v_mul_f32 v165, v165, v15
    v_mfma_f32_16x16x32_bf16 v[76:79], v[92:95], v[156:159], v[76:79]
    v_mul_f32 v166, v166, v15
    v_mul_f32 v167, v167, v15
    v_mul_f32 v168, v168, v15
    v_mul_f32 v169, v169, v15
    v_mul_f32 v170, v170, v15
    v_mul_f32 v171, v171, v15
    v_cvt_pk_bf16_f32 v160, v164, v165
    v_cvt_pk_bf16_f32 v161, v166, v167
    ds_read_b128 v[164:167], v2 offset:35840
    v_cvt_pk_bf16_f32 v162, v168, v169
    v_cvt_pk_bf16_f32 v163, v170, v171
    ds_read_b128 v[168:171], v2 offset:36864
    v_cvt_pk_bf16_f32 v68, v68, v69
    v_mfma_f32_16x16x32_bf16 v[76:79], v[96:99], v[160:163], v[76:79]
    v_cvt_pk_bf16_f32 v69, v70, v71
    v_cvt_pk_bf16_f32 v70, v72, v73
    v_mfma_f32_16x16x32_bf16 v[80:83], v[100:103], v[156:159], v[80:83]
    v_cvt_pk_bf16_f32 v71, v74, v75
    buffer_store_dwordx4 v[68:71], v4, s[8:11], s24 offen offset:0
    v_mfma_f32_16x16x32_bf16 v[80:83], v[104:107], v[160:163], v[80:83]
    v_cvt_pk_bf16_f32 v76, v76, v77
    v_cvt_pk_bf16_f32 v77, v78, v79
    v_mfma_f32_16x16x32_bf16 v[180:183], v[108:111], v[140:143], v[180:183]
    ds_read_b32 v8, v2 offset:63748
    v_mfma_f32_16x16x32_bf16 v[180:183], v[112:115], v[144:147], v[180:183]
    v_cvt_pk_bf16_f32 v78, v80, v81
    v_cvt_pk_bf16_f32 v79, v82, v83
    v_mfma_f32_16x16x32_bf16 v[184:187], v[116:119], v[140:143], v[184:187]
    buffer_store_dwordx4 v[76:79], v4, s[8:11], s25 offen offset:0
    v_mfma_f32_16x16x32_bf16 v[184:187], v[120:123], v[144:147], v[184:187]
    v_cvt_pk_bf16_f32 v180, v180, v181
    v_cvt_pk_bf16_f32 v181, v182, v183
    s_cmp_lt_u32 s17, 9
    s_cbranch_scc1 L_Sloop
    v_mfma_f32_16x16x32_bf16 v[196:199], v[108:111], v[156:159], v[196:199]
    v_mfma_f32_16x16x32_bf16 v[196:199], v[112:115], v[160:163], v[196:199]
    v_cvt_pk_bf16_f32 v182, v184, v185
    v_mfma_f32_16x16x32_bf16 v[200:203], v[116:119], v[156:159], v[200:203]
    v_cvt_pk_bf16_f32 v183, v186, v187
    buffer_store_dwordx4 v[180:183], v4, s[8:11], s24 offen offset:64
    v_mfma_f32_16x16x32_bf16 v[200:203], v[120:123], v[160:163], v[200:203]
    v_cvt_pk_bf16_f32 v196, v196, v197
    v_cvt_pk_bf16_f32 v197, v198, v199
    v_mfma_f32_16x16x32_bf16 v[172:175], v[124:127], v[140:143], v[172:175]
    v_mfma_f32_16x16x32_bf16 v[172:175], v[128:131], v[144:147], v[172:175]
    v_cvt_pk_bf16_f32 v198, v200, v201
    v_cvt_pk_bf16_f32 v199, v202, v203
    v_mfma_f32_16x16x32_bf16 v[176:179], v[132:135], v[140:143], v[176:179]
    buffer_store_dwordx4 v[196:199], v4, s[8:11], s25 offen offset:64
    v_mfma_f32_16x16x32_bf16 v[176:179], v[136:139], v[144:147], v[176:179]
    v_cvt_pk_bf16_f32 v172, v172, v173
    v_cvt_pk_bf16_f32 v173, v174, v175
    v_mfma_f32_16x16x32_bf16 v[188:191], v[124:127], v[156:159], v[188:191]
    v_mfma_f32_16x16x32_bf16 v[188:191], v[128:131], v[160:163], v[188:191]
    v_cvt_pk_bf16_f32 v174, v176, v177
    v_cvt_pk_bf16_f32 v175, v178, v179
    v_mfma_f32_16x16x32_bf16 v[192:195], v[132:135], v[156:159], v[192:195]
    buffer_store_dwordx4 v[172:175], v4, s[8:11], s24 offen offset:128
    v_mfma_f32_16x16x32_bf16 v[192:195], v[136:139], v[160:163], v[192:195]
    v_cvt_pk_bf16_f32 v188, v188, v189
    v_cvt_pk_bf16_f32 v189, v190, v191
    s_nop 5
    v_cvt_pk_bf16_f32 v190, v192, v193
    v_cvt_pk_bf16_f32 v191, v194, v195
    buffer_store_dwordx4 v[188:191], v4, s[8:11], s25 offen offset:128
L_end:
    s_endpgm
L_Sc_slow:
    s_mov_b32 s19, 0x100000
L_Sc_sl:
    ds_read_b32 v8, v2 offset:63748
    s_waitcnt lgkmcnt(0)
    s_sub_u32 s19, s19, 1
    s_cbranch_scc1 L_Sc_back
    v_cmp_le_u32 vcc, s22, v8
    s_nop 0
    s_and_b32 s41, vcc_lo, 15
    s_cmp_lg_u32 s41, 15
    s_cbranch_scc1 L_Sc_sl
L_Sc_up:
    s_branch L_Sc_back
L_Sx_slow:
    s_setprio 0
    s_mov_b32 s19, 0x100000
L_Sx_sl:
    ds_read_b32 v8, v2 offset:63748
    s_waitcnt lgkmcnt(0)
    s_sub_u32 s19, s19, 1
    s_cbranch_scc1 L_Sx_up
    v_cmp_le_u32 vcc, s43, v8
    s_nop 0
    s_and_b32 s41, vcc_lo, 15
    s_cmp_lg_u32 s41, 15
    s_cbranch_scc1 L_Sx_sl
L_Sx_up:
    s_setprio 1
    s_branch L_Sx_back
L_last:
    s_endpgm
.section .rodata,"a"
.p2align 6
.amdhsa_kernel standalone__video_video_swin__vision_kernel
  .amdhsa_next_free_vgpr 256
  .amdhsa_next_free_sgpr 102
  .amdhsa_accum_offset 256
  .amdhsa_group_segment_fixed_size 0
  .amdhsa_kernarg_size 64
  .amdhsa_user_sgpr_count 2
  .amdhsa_user_sgpr_kernarg_segment_ptr 1
  .amdhsa_system_sgpr_workgroup_id_x 1
.end_amdhsa_kernel
```
